```python
import torch

def _softmax(x, axis=-1):
    return torch.softmax(x, dim=axis)
def _gelu(x):
    return torch.nn.functional.gelu(x, approximate="tanh")
def _silu(x):
    return torch.nn.functional.silu(x)
def _sigmoid(x):
    return torch.sigmoid(x)
def _layernorm(x, axis=-1, eps=1e-5):
    m = x.mean(dim=axis, keepdim=True)
    v = x.var(dim=axis, keepdim=True, unbiased=False)
    return (x - m) / torch.sqrt(v + eps)
def _scatter_add(tgt, idx, src, axis=0):
    return tgt.clone().index_add_(axis, idx, src)
def _segment_sum(src, seg, n):
    out = torch.zeros((n,) + src.shape[1:], dtype=src.dtype)
    return out.index_add_(0, seg, src)
def _pad(x, pw):
    flat = tuple(v for pair in reversed(pw) for v in pair)
    return torch.nn.functional.pad(x, flat)

kernel_name = 'recurrent_scan__softmax_full_mha__dense_activation_squared_relu__prompt'

def setup_inputs():

    _w = (lambda a: (lambda t: t.to(torch.bfloat16) if t.is_floating_point() else t)(torch.as_tensor(a)))
    def _A_setup():
        B, S, D = 1, 2048, 512
        return {
            "x": _w((lambda *s: torch.randn(*s, dtype=torch.bfloat16) * 0.05)(B, S, D)),
            "wqkv": _w((lambda *s: torch.randn(*s, dtype=torch.bfloat16) * 0.05)(D, 3 * D)),
            "wo": _w((lambda *s: torch.randn(*s, dtype=torch.bfloat16) * 0.05)(D, D)),
        }
    _A_in = _A_setup()

    def _B_setup():
        B, S, D, F = 1, 2048, 512, 1792
        return {
            "x": _w((lambda *s: torch.randn(*s, dtype=torch.bfloat16) * 0.05)(B, S, D)),
            "w1": _w((lambda *s: torch.randn(*s, dtype=torch.bfloat16) * 0.05)(D, F)),
            "b1": _w((lambda *s: torch.randn(*s, dtype=torch.bfloat16) * 0.4)(F)),
            "w2": _w((lambda *s: torch.randn(*s, dtype=torch.bfloat16) * 0.05)(F, D)),
            "b2": _w((lambda *s: torch.randn(*s, dtype=torch.bfloat16) * 1.6)(D)),
        }
    _B_in = _B_setup()

    return {
        "A_x": _A_in["x"],
        "A_wqkv": _A_in["wqkv"],
        "A_wo": _A_in["wo"],
        "B_x": _B_in["x"],
        "B_w1": _B_in["w1"],
        "B_b1": _B_in["b1"],
        "B_w2": _B_in["w2"],
        "B_b2": _B_in["b2"],
    }

def reference(A_x, A_wqkv, A_wo, B_x, B_w1, B_b1, B_w2, B_b2):
    def _A_ref(x, wqkv, wo):
        B, S, D = x.shape
        H = 32; Dh = D // H
        qkv = (lambda x, *d: x.permute(*d))((x @ wqkv).reshape(B, S, 3, H, Dh), 2, 0, 3, 1, 4)
        q, k, v = qkv[0], qkv[1], qkv[2]
        scale = Dh ** -0.5
        scores = torch.einsum("bhqd,bhkd->bhqk", q, k) * scale
        p = _softmax(scores, axis=-1)
        o = torch.einsum("bhqk,bhkd->bhqd", p, v)
        return (lambda x, *d: x.permute(*d))(o, 0, 2, 1, 3).reshape(B, S, D) @ wo

    def _B_ref(x, w1, b1, w2, b2):
        h = torch.einsum("bsd,df->bsf", x, w1) + b1
        zero = torch.zeros_like(h)
        r = torch.where(h > zero, h, zero)
        h = r * r
        out = torch.einsum("bsf,fd->bsd", h, w2) + b2
        return out

    x = A_x
    xn = _layernorm(x, axis=-1)
    s = _A_ref(xn, A_wqkv, A_wo)
    g = _silu(_B_ref(xn, B_w1, B_b1, B_w2, B_b2))
    return x + s * g
```

```asm
; @launch grid=(256,1,1) block=(512,1,1) lds=163840
.amdgcn_target "amdgcn-amd-amdhsa--gfx950"
.text
.p2align 12
.globl recurrent_scan__softmax_full_mha__dense_activation_squared_relu__prompt_kernel
.p2align 8
.type recurrent_scan__softmax_full_mha__dense_activation_squared_relu__prompt_kernel,@function
recurrent_scan__softmax_full_mha__dense_activation_squared_relu__prompt_kernel:
    s_cmp_ge_u32 s2, 256
    s_cbranch_scc1 END
    s_load_dwordx16 s[40:55], s[0:1], 0
    s_load_dwordx4 s[56:59], s[0:1], 64
    s_load_dwordx2 s[60:61], s[0:1], 80
    s_memrealtime s[96:97]
    v_lshrrev_b32 v4, 6, v0
    v_and_b32 v1, 63, v0
    v_lshlrev_b32 v253, 2, v0
    v_readfirstlane_b32 s62, v4
    s_and_b32 s100, s2, 7
    s_lshr_b32 s101, s2, 3
    s_sub_u32 s64, 7, s62
    s_cmp_ge_u32 s64, 2
    s_cbranch_scc1 SC_BACK
    s_lshl_b32 s64, s64, 5
    s_add_u32 s64, s64, s101
    s_mov_b64 exec, 0
    s_bitcmp1_b32 s64, 5
    s_cbranch_scc1 SC_BACK
    s_bitcmp1_b32 s64, 4
    s_cbranch_scc1 SC_16
    s_bitcmp1_b32 s64, 3
    s_cbranch_scc1 SC_8
    s_bitcmp1_b32 s64, 2
    s_cbranch_scc1 SC_4
    s_bitcmp1_b32 s64, 1
    s_cbranch_scc1 SC_2
    s_bitcmp1_b32 s64, 0
    s_cbranch_scc1 PAD1
    s_branch PAD0
SC_2:
    s_bitcmp1_b32 s64, 0
    s_cbranch_scc1 PAD3
    s_branch PAD2
SC_4:
    s_bitcmp1_b32 s64, 1
    s_cbranch_scc1 SC_6
    s_bitcmp1_b32 s64, 0
    s_cbranch_scc1 PAD5
    s_branch PAD4
SC_6:
    s_bitcmp1_b32 s64, 0
    s_cbranch_scc1 PAD7
    s_branch PAD6
SC_8:
    s_bitcmp1_b32 s64, 2
    s_cbranch_scc1 SC_12
    s_bitcmp1_b32 s64, 1
    s_cbranch_scc1 SC_10
    s_bitcmp1_b32 s64, 0
    s_cbranch_scc1 PAD9
    s_branch PAD8
SC_10:
    s_bitcmp1_b32 s64, 0
    s_cbranch_scc1 PAD11
    s_branch PAD10
SC_12:
    s_bitcmp1_b32 s64, 1
    s_cbranch_scc1 SC_14
    s_bitcmp1_b32 s64, 0
    s_cbranch_scc1 PAD13
    s_branch PAD12
SC_14:
    s_bitcmp1_b32 s64, 0
    s_cbranch_scc1 PAD15
    s_branch PAD14
SC_16:
    s_bitcmp1_b32 s64, 3
    s_cbranch_scc1 SC_24
    s_bitcmp1_b32 s64, 2
    s_cbranch_scc1 SC_20
    s_bitcmp1_b32 s64, 1
    s_cbranch_scc1 SC_18
    s_bitcmp1_b32 s64, 0
    s_cbranch_scc1 PAD17
    s_branch PAD16
SC_18:
    s_bitcmp1_b32 s64, 0
    s_cbranch_scc1 PAD19
    s_branch PAD18
SC_20:
    s_bitcmp1_b32 s64, 1
    s_cbranch_scc1 SC_22
    s_bitcmp1_b32 s64, 0
    s_cbranch_scc1 PAD21
    s_branch PAD20
SC_22:
    s_bitcmp1_b32 s64, 0
    s_cbranch_scc1 PAD23
    s_branch PAD22
SC_24:
    s_bitcmp1_b32 s64, 2
    s_cbranch_scc1 SC_BACK
    s_bitcmp1_b32 s64, 1
    s_cbranch_scc1 SC_26
    s_bitcmp1_b32 s64, 0
    s_cbranch_scc1 PAD25
    s_branch PAD24
SC_26:
    s_bitcmp1_b32 s64, 0
    s_cbranch_scc1 PAD27
    s_branch PAD26
SC_BACK:
    s_mov_b64 exec, -1
    s_lshr_b32 s64, s100, 2
    s_lshl_b32 s64, s64, 3
    s_and_b32 s65, s101, 7
    s_add_u32 s64, s64, s65
    s_and_b32 s91, s100, 3
    s_lshl_b32 s91, s91, 2
    s_lshr_b32 s65, s101, 3
    s_add_u32 s91, s91, s65
    s_xor_b32 s3, s65, s101
    s_and_b32 s3, s3, 3
    s_lshl_b32 s68, s64, 17
    s_lshl_b32 s65, s62, 14
    s_add_u32 s68, s68, s65
    s_lshl_b32 s65, s3, 7
    s_add_u32 s68, s68, s65
    s_and_b32 s63, s62, 3
    s_and_b32 s65, s101, 1
    s_lshl2_add_u32 s65, s65, s63
    s_lshl_b32 s65, s65, 3
    s_cmp_lt_u32 s62, 4
    s_cselect_b32 s65, 64, s65
    s_load_dwordx2 s[36:37], s[0:1], s65 offset:16
    s_lshl_b32 s89, s64, 2
    s_add_u32 s89, s89, s63
    s_lshl_b32 s71, s62, 11
    s_lshl_b32 s72, s62, 10
    s_and_b32 s65, s91, 1
    s_mul_i32 s66, s91, 3
    s_sub_u32 s66, s66, s65
    s_mul_i32 s98, s62, 24576
    s_lshl_b32 s67, s66, 6
    s_add_u32 s98, s98, s67
    s_mul_i32 s69, s3, 196608
    s_add_u32 s69, s69, s98
    v_lshrrev_b32 v4, 3, v1
    v_lshrrev_b32 v5, 4, v1
    v_and_b32 v6, 7, v1
    v_xor_b32 v7, v6, v5
    v_lshlrev_b32 v7, 4, v7
    v_lshl_add_u32 v216, v4, 10, v7
    v_xor_b32 v217, 64, v216
    v_add_u32 v217, 0x2000, v217
    v_and_b32 v5, 1, v5
    v_lshlrev_b32 v5, 2, v5
    v_xor_b32 v6, v6, v5
    v_lshlrev_b32 v6, 4, v6
    v_lshl_add_u32 v220, v4, 10, v6
    s_movk_i32 s67, 3072
    v_mad_u32_u24 v218, v4, s67, v6
    v_lshrrev_b32 v5, 2, v1
    v_and_b32 v7, 3, v1
    s_lshl_b32 s64, s65, 7
    v_lshl_add_u32 v5, s63, 3, v5
    v_add_u32 v218, s64, v218
    s_lshr_b32 s64, 128, s65
    v_lshl_add_u32 v7, v7, 4, s64
    v_mad_u32_u24 v213, v5, s67, v7
    s_movk_i32 s67, 3584
    v_mad_u32_u24 v219, v4, s67, v6
    s_lshl_b32 s64, s65, 1
    s_sub_u32 s67, 2, s65
    s_cmp_lt_u32 s62, 4
    s_cselect_b32 s64, s64, s67
    s_cselect_b64 s[86:87], 0, -1
    s_add_u32 s66, s66, s64
    s_lshl_b32 s74, s66, 17
    s_lshl_b32 s67, s89, 10
    s_add_u32 s74, s74, s67
    s_mov_b32 s77, 0
    s_waitcnt lgkmcnt(0)
    s_load_dword s95, s[42:43], s69
    s_load_dword s95, s[40:41], s68
    s_mov_b32 s4, s40
    s_and_b32 s5, s41, 0xffff
    s_mov_b32 s6, 0x200000
    s_mov_b32 s7, 0x20000
    s_mov_b32 s8, s42
    s_and_b32 s9, s43, 0xffff
    s_mov_b32 s10, 0x180000
    s_mov_b32 s11, 0x20000
    s_cmp_ge_u32 s62, 4
    s_cbranch_scc1 NOA0
    s_add_u32 m0, s71, 0x2000
    s_add_u32 s67, s68, 65536
    buffer_load_dwordx4 v216, s[4:7], s67 offen lds
    s_add_u32 m0, s71, 0x0
    s_nop 0
    buffer_load_dwordx4 v216, s[4:7], s68 offen lds
    s_add_u32 m0, s72, 0x5000
    s_add_u32 s67, s69, 98304
    buffer_load_dwordx4 v218, s[8:11], s67 offen lds
    s_add_u32 m0, s72, 0x4000
    s_nop 0
    buffer_load_dwordx4 v218, s[8:11], s69 offen lds
    s_add_u32 m0, s71, 0x2400
    s_add_u32 s67, s68, 65536
    buffer_load_dwordx4 v217, s[4:7], s67 offen lds
    s_add_u32 m0, s71, 0x400
    s_nop 0
    buffer_load_dwordx4 v217, s[4:7], s68 offen lds
    s_add_u32 m0, s72, 0x6000
    s_nop 0
    buffer_load_dwordx4 v213, s[8:11], s69 offen lds
NOA0:
    s_xor_b32 s68, s68, 128
    s_xor_b32 s69, s3, 1
    s_mul_i32 s69, s69, 196608
    s_add_u32 s69, s69, s98
    s_mov_b32 s32, s58
    s_and_b32 s33, s59, 0xffff
    s_mov_b32 s34, 0x100
    s_mov_b32 s35, 0x20000
    s_or_b32 s67, s2, s62
    s_cbranch_scc1 NOEP
    s_or_b32 s96, s96, 1
    v_mov_b32 v3, s96
    s_mov_b64 exec, 1
    buffer_store_dword v3, off, s[32:35], 0 sc1
    s_mov_b64 exec, -1
NOEP:
    s_mov_b32 s12, s48
    s_and_b32 s13, s49, 0xffff
    s_mov_b32 s14, 0x1c0000
    s_mov_b32 s15, 0x20000
    s_lshr_b32 s67, s91, 3
    s_mul_i32 s67, s67, 28
    s_and_b32 s84, s91, 3
    s_mul_i32 s85, s84, 3
    s_sub_u32 s85, s85, s65
    s_add_u32 s85, s85, 16
    s_lshl_b32 s84, s84, 2
    s_bfe_u32 s64, s91, 0x10002
PAD0:
    s_cbranch_execz SC_BACK
    s_cselect_b32 s84, s85, s84
    s_mov_b32 s94, s64
    s_add_u32 s67, s67, s84
    s_mul_i32 s99, s62, 28672
    s_lshl_b32 s84, s67, 6
    s_add_u32 s99, s99, s84
    s_mul_i32 s70, s3, 229376
    s_add_u32 s70, s70, s99
    s_and_b32 s64, s64, s65
    s_lshl_b32 s84, s64, 1
    s_sub_u32 s85, 2, s64
    s_cmp_lt_u32 s62, 4
    s_cselect_b32 s64, s84, s85
    s_cselect_b32 s94, 0, s94
    s_add_u32 s67, s67, s64
    s_and_b32 s78, s64, 1
    s_lshl_b32 s78, s78, 6
    s_lshr_b32 s64, s64, 1
    s_lshl_b32 s64, s64, 13
    s_or_b32 s78, s78, s64
    s_lshl_b32 s64, s63, 11
    s_or_b32 s77, s77, s64
    s_or_b32 s78, s78, s64
    s_or_b32 s78, s78, 0x20000
    s_mul_i32 s75, s89, 114688
    s_lshl_b32 s64, s67, 11
    s_add_u32 s75, s75, s64
    s_add_u32 s75, s75, 0x600000
    s_mov_b32 s24, s50
    s_and_b32 s25, s51, 0xffff
    s_mov_b32 s26, 0xe00
    s_mov_b32 s27, 0x20000
    v_and_b32 v4, 31, v1
    v_lshlrev_b32 v5, 1, v4
    s_lshl_b32 s64, s67, 6
    v_add_u32 v235, s64, v5
    s_mov_b32 s90, 0x3eb8aa3b
    s_cmp_lt_u32 s66, 16
    s_cselect_b32 s90, s90, 1.0
    s_cmp_ge_u32 s66, 32
    s_cselect_b64 vcc, -1, 0
    v_lshlrev_b32 v2, 4, v1
    v_lshrrev_b32 v5, 5, v1
    v_lshlrev_b32 v6, 4, v5
    v_lshl_add_u32 v6, v4, 5, v6
    v_cndmask_b32 v236, v2, v6, vcc
    s_mov_b32 s16, s60
    s_and_b32 s17, s61, 0xffff
    s_mov_b32 s18, 0x10000000
    s_mov_b32 s19, 0x20000
    s_lshl_b32 s64, s89, 15
    s_mul_i32 s58, s91, 3
    s_and_b32 s58, s58, 15
    s_lshl_b32 s58, s58, 11
    s_add_u32 s64, s64, s58
    s_add_u32 s64, s64, 0x1000000
    s_cmp_lt_u32 s62, 4
    s_cselect_b32 s58, 0, s64
    v_mov_b32 v204, -1
    v_mov_b32 v205, -1
    v_mov_b32 v206, -1
    v_mov_b32 v207, -1
    s_bfe_u32 s64, s89, 0x10002
    s_lshl_b32 s64, s64, 4
    s_add_u32 s64, s64, s91
    s_lshr_b32 s66, s64, 1
    s_add_u32 s66, s66, 128
    s_lshl_b32 s64, s64, 2
    s_add_u32 s64, s64, s63
    s_cmp_eq_u32 s65, 0
    s_cselect_b32 s66, 0x1fff, s66
    s_cmp_eq_u32 s62, 0
    s_cselect_b32 s66, s66, 0x1fff
    s_cmp_ge_u32 s62, 4
    s_cselect_b32 s64, s64, s66
    s_lshl_b32 s64, s64, 3
    s_lshr_b32 s66, s89, 3
    s_add_u32 s64, s64, s66
    s_lshl_b32 s76, s64, 11
    s_add_u32 s76, s76, 0xd00000
    s_cmp_lt_u32 s64, 896
    s_cselect_b32 s20, s52, s44
    s_cselect_b32 s21, s53, s45
    s_and_b32 s21, s21, 0xffff
    s_mov_b32 s22, 0x1c0000
    s_cmp_lt_u32 s64, 896
    s_cselect_b32 s22, s22, 0x80000
    s_cselect_b32 s66, 0, 896
    s_mov_b32 s23, 0x20000
    s_sub_u32 s64, s64, s66
    s_lshr_b32 s66, s64, 3
    s_lshl_b32 s66, s66, 14
    s_and_b32 s64, s64, 7
    s_lshl_b32 s64, s64, 7
    s_add_u32 s47, s64, s66
    s_lshl_b32 s64, s100, 2
    s_and_b32 s65, s101, 3
    s_add_u32 s64, s64, s65
    s_lshr_b32 s65, s101, 2
    s_lshl_b32 s65, s65, 3
    s_lshl_b32 s66, s63, 1
    s_add_u32 s65, s65, s66
    s_lshl_b32 s81, s64, 16
    s_lshr_b32 s66, s62, 2
    s_add_u32 s65, s65, s66
    s_lshl_b32 s66, s65, 10
    s_xor_b32 s66, s66, 1024
    s_add_u32 s81, s81, s66
    s_lshl_b32 s88, s65, 15
    s_lshl_b32 s66, s64, 10
    s_add_u32 s88, s88, s66
    s_add_u32 s88, s88, 0x1000000
    s_lshr_b32 s65, s64, 1
    s_add_u32 s66, s65, 16
    s_mul_i32 s66, s66, 43
    s_lshr_b32 s66, s66, 7
    s_mul_i32 s66, s66, 4352
    s_add_u32 s66, s66, 0x1500000
    s_add_u32 s67, s65, 32
    s_mul_i32 s67, s67, 43
    s_lshr_b32 s67, s67, 7
    s_mul_i32 s67, s67, 4352
    s_add_u32 s67, s67, 0x1500000
    s_add_u32 s84, s65, 0
    s_mul_i32 s84, s84, 43
    s_lshr_b32 s84, s84, 7
    s_mul_i32 s84, s84, 4352
    s_add_u32 s84, s84, 0x1500000
    s_lshr_b32 s65, s101, 2
    s_lshl_b32 s65, s65, 3
    s_add_u32 s84, s84, s65
    v_and_b32 v6, 1, v1
    v_lshl_add_u32 v239, v6, 2, s84
    v_and_b32 v6, 15, v1
    s_mov_b64 exec, 0xffff
    v_lshl_add_u32 v239, v6, 2, s66
    s_mov_b32 exec_lo, 0xffff0000
    v_lshl_add_u32 v239, v6, 2, s67
    s_mov_b64 exec, -1
    s_and_b32 s65, s62, 1
    s_lshl_b32 s80, s65, 10
    s_lshl_b32 s65, s65, 5
    s_add_u32 s64, s64, s65
    s_add_u32 s64, s64, 32
    s_lshl_b32 s79, s64, 16
    s_lshr_b32 s65, s62, 1
    s_lshl_b32 s66, s65, 10
    s_add_u32 s79, s79, s66
    s_lshr_b32 s66, s101, 2
    s_lshl_b32 s66, s66, 13
    s_add_u32 s79, s79, s66
    s_mul_i32 s65, s65, 2064
    s_add_u32 s80, s80, s65
    s_and_b32 s65, s101, 3
    s_lshl2_add_u32 s92, s100, s65
    s_lshr_b32 s93, s101, 2
    s_mul_i32 s82, s92, 229376
    s_mul_i32 s65, s62, 14336
    s_add_u32 s82, s82, s65
    s_add_u32 s82, s82, 0x600000
    s_add_u32 s59, s82, 114688
    s_cmp_lt_u32 s62, 4
    s_cselect_b32 s65, s82, s59
    s_cselect_b32 s59, s59, s82
    s_mov_b32 s82, s65
    s_mul_i32 s83, s62, 229376
    s_lshl_b32 s65, s93, 11
    s_add_u32 s83, s83, s65
    s_add_u32 s83, s83, 0xd00000
    s_and_b32 s65, s101, 3
    s_lshl2_add_u32 s65, s65, s63
    s_lshl_b32 s65, s65, 21
    s_cmp_lt_u32 s62, 4
    s_cselect_b32 s65, s65, 0
    s_load_dword s95, s[36:37], s65
    s_mov_b32 s28, s54
    s_and_b32 s29, s55, 0xffff
    s_mov_b32 s30, 0x400
    s_mov_b32 s31, 0x20000
    s_mov_b32 s36, s56
    s_and_b32 s37, s57, 0xffff
    s_mov_b32 s38, 0x200000
    s_mov_b32 s39, 0x20000
    s_lshr_b32 s64, s89, 2
    s_mul_i32 s45, s91, 4352
    s_lshl_b32 s65, s64, 2
    s_add_u32 s45, s45, s65
    s_add_u32 s45, s45, 0x1500000
    s_mul_i32 s46, s64, 4352
    s_lshl_b32 s65, s91, 2
    s_add_u32 s46, s46, s65
    s_add_u32 s46, s46, 0x1520000
    s_mov_b32 s73, 0xffff0000
    v_bfe_u32 v6, v1, 1, 3
    v_xor_b32 v6, v6, v5
    v_lshlrev_b32 v6, 4, v6
    v_lshl_add_u32 v6, v4, 7, v6
    s_lshl_b32 s64, s63, 12
    s_lshl_b32 s65, s63, 5
    s_or_b32 s64, s64, s65
    v_xor_b32 v221, s64, v6
    v_xor_b32 v222, 32, v221
    v_xor_b32 v223, 64, v221
    v_xor_b32 v224, 96, v221
    v_bfe_u32 v6, v1, 2, 2
    v_lshlrev_b32 v6, 7, v6
    v_bfe_u32 v7, v1, 3, 1
    v_lshl_add_u32 v6, v7, 6, v6
PAD1:
    s_cbranch_execz SC_BACK
    v_bfe_u32 v7, v1, 4, 1
    v_lshl_add_u32 v6, v7, 5, v6
    v_and_b32 v7, 3, v1
    v_lshl_add_u32 v6, v7, 3, v6
    v_lshl_add_u32 v237, v5, 10, v6
    v_lshl_add_u32 v238, v5, 9, v6
    s_xor_b32 s64, s71, 155648
    v_add_u32 v238, s64, v238
    v_xor_b32 v225, s77, v237
    v_xor_b32 v226, 64, v225
    v_xor_b32 v227, 2048, v225
    v_xor_b32 v228, 2112, v225
    v_xor_b32 v229, 4096, v225
    v_xor_b32 v230, 4160, v225
    v_xor_b32 v231, 6144, v225
    v_xor_b32 v232, 6208, v225
    v_xor_b32 v237, s78, v237
    v_lshrrev_b32 v6, 4, v1
    v_lshrrev_b32 v7, 2, v1
    v_xor_b32 v6, v6, v7
    v_and_b32 v6, 1, v6
    v_and_or_b32 v6, v1, 3, v6
    v_cmp_eq_u32 vcc, 0, v6
    v_mov_b32 v7, 0x3f803f80
    v_mov_b32 v212, 0
    v_cndmask_b32 v200, 0, v7, vcc
    v_mov_b32 v201, v200
    v_mov_b32 v202, v200
    v_mov_b32 v203, v200
    s_lshr_b32 s64, s62, 2
    s_mul_i32 s64, s64, 2064
    v_add_u32 v248, s64, v2
    v_bfe_u32 v6, v1, 1, 1
    v_lshlrev_b32 v6, 3, v6
    v_add_u32 v6, s64, v6
    v_and_b32 v7, 1, v1
    v_lshl_add_u32 v255, v7, 4, v6
    v_bfe_u32 v7, v1, 2, 2
    v_lshl_add_u32 v255, v7, 5, v255
    v_lshl_add_u32 v255, v5, 8, v255
    v_add_u32 v6, 2048, v6
    v_and_b32 v7, 16, v1
    v_cmp_eq_u32 vcc, 0, v7
    s_nop 0
    v_add_u32 v7, 1024, v255
    v_cndmask_b32 v249, v6, v7, vcc
    v_add_u32 v7, 1152, v255
    v_cndmask_b32 v250, v6, v7, vcc
    v_add_u32 v7, 1536, v255
    v_cndmask_b32 v251, v6, v7, vcc
    v_add_u32 v7, 1664, v255
    v_cndmask_b32 v252, v6, v7, vcc
    v_add_u32 v253, 137216, v253
    v_xor_b32 v254, 1024, v253
    v_mov_b32 v7, 132084
    v_cndmask_b32 v254, v7, v254, s[86:87]
    s_mov_b64 exec, 0
    s_cmp_eq_u32 s62, 0
    s_cbranch_scc1 QAD0
    s_cmp_eq_u32 s62, 1
    s_cbranch_scc1 QAD1
    s_cmp_eq_u32 s62, 2
    s_cbranch_scc1 QAD2
    s_cmp_eq_u32 s62, 3
    s_cbranch_scc1 QAD3
VRET:
    s_mov_b64 exec, -1
    s_cmp_ge_u32 s62, 4
    s_cbranch_scc1 A_HI
    s_waitcnt vmcnt(0)
    s_barrier
    ds_read_b128 v[16:19], v221 offset:0
    ds_read_b64_tr_b16 v[176:177], v225 offset:16384
    ds_read_b64_tr_b16 v[178:179], v225 offset:16896
    ds_read_b64_tr_b16 v[180:181], v226 offset:16384
    ds_read_b64_tr_b16 v[182:183], v226 offset:16896
    ds_read_b128 v[20:23], v222 offset:0
    ds_read_b64_tr_b16 v[184:185], v227 offset:16384
    ds_read_b64_tr_b16 v[186:187], v227 offset:16896
    ds_read_b64_tr_b16 v[188:189], v228 offset:16384
    ds_read_b64_tr_b16 v[190:191], v228 offset:16896
    s_waitcnt lgkmcnt(7)
    v_mfma_f32_32x32x16_bf16 v[144:159], v[176:179], v[16:19], 0
    ds_read_b128 v[24:27], v223 offset:0
    ds_read_b64_tr_b16 v[240:241], v229 offset:16384
    ds_read_b64_tr_b16 v[242:243], v229 offset:16896
    s_waitcnt lgkmcnt(8)
    v_mfma_f32_32x32x16_bf16 v[160:175], v[180:183], v[16:19], 0
    ds_read_b64_tr_b16 v[244:245], v230 offset:16384
    ds_read_b64_tr_b16 v[246:247], v230 offset:16896
    v_mfma_f32_16x16x32_bf16 v[192:195], v[200:203], v[176:179], 0
    v_mfma_f32_16x16x32_bf16 v[196:199], v[200:203], v[180:183], 0
    s_waitcnt lgkmcnt(7)
    v_mfma_f32_32x32x16_bf16 v[144:159], v[184:187], v[20:23], v[144:159]
    ds_read_b128 v[28:31], v224 offset:0
    ds_read_b64_tr_b16 v[176:177], v231 offset:16384
    ds_read_b64_tr_b16 v[178:179], v231 offset:16896
    s_waitcnt lgkmcnt(8)
    v_mfma_f32_32x32x16_bf16 v[160:175], v[188:191], v[20:23], v[160:175]
    ds_read_b64_tr_b16 v[180:181], v232 offset:16384
    ds_read_b64_tr_b16 v[182:183], v232 offset:16896
    s_waitcnt lgkmcnt(7)
    v_mfma_f32_32x32x16_bf16 v[144:159], v[240:243], v[24:27], v[144:159]
    s_waitcnt lgkmcnt(0)
    s_barrier
    ds_read_b128 v[32:35], v221 offset:32768
    ds_read_b64_tr_b16 v[184:185], v225 offset:49152
    ds_read_b64_tr_b16 v[186:187], v225 offset:49664
    v_mfma_f32_32x32x16_bf16 v[160:175], v[244:247], v[24:27], v[160:175]
    ds_read_b64_tr_b16 v[188:189], v226 offset:49152
    ds_read_b64_tr_b16 v[190:191], v226 offset:49664
    v_mfma_f32_32x32x16_bf16 v[144:159], v[176:179], v[28:31], v[144:159]
    ds_read_b128 v[36:39], v222 offset:32768
    ds_read_b64_tr_b16 v[240:241], v227 offset:49152
    ds_read_b64_tr_b16 v[242:243], v227 offset:49664
    v_mfma_f32_32x32x16_bf16 v[160:175], v[180:183], v[28:31], v[160:175]
    ds_read_b64_tr_b16 v[244:245], v228 offset:49152
    ds_read_b64_tr_b16 v[246:247], v228 offset:49664
    s_waitcnt lgkmcnt(7)
    v_mfma_f32_32x32x16_bf16 v[144:159], v[184:187], v[32:35], v[144:159]
    ds_read_b128 v[40:43], v223 offset:32768
    ds_read_b64_tr_b16 v[176:177], v229 offset:49152
    ds_read_b64_tr_b16 v[178:179], v229 offset:49664
    s_waitcnt lgkmcnt(8)
    v_mfma_f32_32x32x16_bf16 v[160:175], v[188:191], v[32:35], v[160:175]
    ds_read_b64_tr_b16 v[180:181], v230 offset:49152
    ds_read_b64_tr_b16 v[182:183], v230 offset:49664
    v_mfma_f32_16x16x32_bf16 v[192:195], v[200:203], v[184:187], v[192:195]
    v_mfma_f32_16x16x32_bf16 v[196:199], v[200:203], v[188:191], v[196:199]
    s_waitcnt lgkmcnt(7)
    v_mfma_f32_32x32x16_bf16 v[144:159], v[240:243], v[36:39], v[144:159]
    ds_read_b128 v[44:47], v224 offset:32768
    ds_read_b64_tr_b16 v[184:185], v231 offset:49152
    ds_read_b64_tr_b16 v[186:187], v231 offset:49664
    s_waitcnt lgkmcnt(8)
    v_mfma_f32_32x32x16_bf16 v[160:175], v[244:247], v[36:39], v[160:175]
    ds_read_b64_tr_b16 v[188:189], v232 offset:49152
    ds_read_b64_tr_b16 v[190:191], v232 offset:49664
    s_waitcnt lgkmcnt(7)
    v_mfma_f32_32x32x16_bf16 v[144:159], v[176:179], v[40:43], v[144:159]
    s_waitcnt lgkmcnt(0)
    s_barrier
    v_xor_b32 v221, 0x10000, v221
    ds_read_b128 v[48:51], v221 offset:0
    v_xor_b32 v225, 0x10000, v225
    ds_read_b64_tr_b16 v[240:241], v225 offset:16384
    ds_read_b64_tr_b16 v[242:243], v225 offset:16896
    v_mfma_f32_32x32x16_bf16 v[160:175], v[180:183], v[40:43], v[160:175]
    v_xor_b32 v226, 0x10000, v226
    ds_read_b64_tr_b16 v[244:245], v226 offset:16384
    ds_read_b64_tr_b16 v[246:247], v226 offset:16896
    v_mfma_f32_32x32x16_bf16 v[144:159], v[184:187], v[44:47], v[144:159]
    v_xor_b32 v222, 0x10000, v222
    ds_read_b128 v[52:55], v222 offset:0
    v_xor_b32 v227, 0x10000, v227
    ds_read_b64_tr_b16 v[176:177], v227 offset:16384
    ds_read_b64_tr_b16 v[178:179], v227 offset:16896
    v_mfma_f32_32x32x16_bf16 v[160:175], v[188:191], v[44:47], v[160:175]
    v_xor_b32 v228, 0x10000, v228
    ds_read_b64_tr_b16 v[180:181], v228 offset:16384
    ds_read_b64_tr_b16 v[182:183], v228 offset:16896
    s_waitcnt lgkmcnt(7)
    v_mfma_f32_32x32x16_bf16 v[144:159], v[240:243], v[48:51], v[144:159]
    v_xor_b32 v223, 0x10000, v223
PAD2:
    s_cbranch_execz SC_BACK
    ds_read_b128 v[56:59], v223 offset:0
    v_xor_b32 v229, 0x10000, v229
    ds_read_b64_tr_b16 v[184:185], v229 offset:16384
    ds_read_b64_tr_b16 v[186:187], v229 offset:16896
    s_waitcnt lgkmcnt(8)
    v_mfma_f32_32x32x16_bf16 v[160:175], v[244:247], v[48:51], v[160:175]
    v_xor_b32 v230, 0x10000, v230
    ds_read_b64_tr_b16 v[188:189], v230 offset:16384
    ds_read_b64_tr_b16 v[190:191], v230 offset:16896
    v_mfma_f32_16x16x32_bf16 v[192:195], v[200:203], v[240:243], v[192:195]
    v_mfma_f32_16x16x32_bf16 v[196:199], v[200:203], v[244:247], v[196:199]
    s_waitcnt lgkmcnt(7)
    v_mfma_f32_32x32x16_bf16 v[144:159], v[176:179], v[52:55], v[144:159]
    v_xor_b32 v224, 0x10000, v224
    ds_read_b128 v[60:63], v224 offset:0
    v_xor_b32 v231, 0x10000, v231
    ds_read_b64_tr_b16 v[240:241], v231 offset:16384
    ds_read_b64_tr_b16 v[242:243], v231 offset:16896
    s_waitcnt lgkmcnt(8)
    v_mfma_f32_32x32x16_bf16 v[160:175], v[180:183], v[52:55], v[160:175]
    v_xor_b32 v232, 0x10000, v232
    ds_read_b64_tr_b16 v[244:245], v232 offset:16384
    ds_read_b64_tr_b16 v[246:247], v232 offset:16896
    s_waitcnt lgkmcnt(7)
    v_mfma_f32_32x32x16_bf16 v[144:159], v[184:187], v[56:59], v[144:159]
    s_waitcnt lgkmcnt(0)
    s_barrier
    ds_read_b128 v[64:67], v221 offset:32768
    ds_read_b64_tr_b16 v[176:177], v225 offset:49152
    ds_read_b64_tr_b16 v[178:179], v225 offset:49664
    v_mfma_f32_32x32x16_bf16 v[160:175], v[188:191], v[56:59], v[160:175]
    ds_read_b64_tr_b16 v[180:181], v226 offset:49152
    ds_read_b64_tr_b16 v[182:183], v226 offset:49664
    v_mfma_f32_32x32x16_bf16 v[144:159], v[240:243], v[60:63], v[144:159]
    ds_read_b128 v[68:71], v222 offset:32768
    ds_read_b64_tr_b16 v[184:185], v227 offset:49152
    ds_read_b64_tr_b16 v[186:187], v227 offset:49664
    v_mfma_f32_32x32x16_bf16 v[160:175], v[244:247], v[60:63], v[160:175]
    ds_read_b64_tr_b16 v[188:189], v228 offset:49152
    ds_read_b64_tr_b16 v[190:191], v228 offset:49664
    s_waitcnt lgkmcnt(7)
    v_mfma_f32_32x32x16_bf16 v[144:159], v[176:179], v[64:67], v[144:159]
    ds_read_b128 v[72:75], v223 offset:32768
    ds_read_b64_tr_b16 v[240:241], v229 offset:49152
    ds_read_b64_tr_b16 v[242:243], v229 offset:49664
    s_waitcnt lgkmcnt(8)
    v_mfma_f32_32x32x16_bf16 v[160:175], v[180:183], v[64:67], v[160:175]
    ds_read_b64_tr_b16 v[244:245], v230 offset:49152
    ds_read_b64_tr_b16 v[246:247], v230 offset:49664
    v_mfma_f32_16x16x32_bf16 v[192:195], v[200:203], v[176:179], v[192:195]
    v_mfma_f32_16x16x32_bf16 v[196:199], v[200:203], v[180:183], v[196:199]
    s_waitcnt lgkmcnt(7)
    v_mfma_f32_32x32x16_bf16 v[144:159], v[184:187], v[68:71], v[144:159]
    ds_read_b128 v[76:79], v224 offset:32768
    ds_read_b64_tr_b16 v[176:177], v231 offset:49152
    ds_read_b64_tr_b16 v[178:179], v231 offset:49664
    s_waitcnt lgkmcnt(8)
    v_mfma_f32_32x32x16_bf16 v[160:175], v[188:191], v[68:71], v[160:175]
    ds_read_b64_tr_b16 v[180:181], v232 offset:49152
    ds_read_b64_tr_b16 v[182:183], v232 offset:49664
    s_waitcnt lgkmcnt(7)
    v_mfma_f32_32x32x16_bf16 v[144:159], v[240:243], v[72:75], v[144:159]
    s_waitcnt lgkmcnt(0)
    s_barrier
    v_xor_b32 v221, 0x10000, v221
    ds_read_b128 v[80:83], v221 offset:0
    v_xor_b32 v225, 0x10000, v225
    ds_read_b64_tr_b16 v[184:185], v225 offset:16384
    ds_read_b64_tr_b16 v[186:187], v225 offset:16896
    v_mfma_f32_32x32x16_bf16 v[160:175], v[244:247], v[72:75], v[160:175]
    v_xor_b32 v226, 0x10000, v226
    ds_read_b64_tr_b16 v[188:189], v226 offset:16384
    ds_read_b64_tr_b16 v[190:191], v226 offset:16896
    v_mfma_f32_32x32x16_bf16 v[144:159], v[176:179], v[76:79], v[144:159]
    v_xor_b32 v222, 0x10000, v222
    ds_read_b128 v[84:87], v222 offset:0
    v_xor_b32 v227, 0x10000, v227
    ds_read_b64_tr_b16 v[240:241], v227 offset:16384
    ds_read_b64_tr_b16 v[242:243], v227 offset:16896
    v_mfma_f32_32x32x16_bf16 v[160:175], v[180:183], v[76:79], v[160:175]
    v_xor_b32 v228, 0x10000, v228
    ds_read_b64_tr_b16 v[244:245], v228 offset:16384
    ds_read_b64_tr_b16 v[246:247], v228 offset:16896
    s_waitcnt lgkmcnt(7)
    v_mfma_f32_32x32x16_bf16 v[144:159], v[184:187], v[80:83], v[144:159]
    v_xor_b32 v223, 0x10000, v223
    ds_read_b128 v[88:91], v223 offset:0
    v_xor_b32 v229, 0x10000, v229
    ds_read_b64_tr_b16 v[176:177], v229 offset:16384
    ds_read_b64_tr_b16 v[178:179], v229 offset:16896
    s_waitcnt lgkmcnt(8)
    v_mfma_f32_32x32x16_bf16 v[160:175], v[188:191], v[80:83], v[160:175]
    v_xor_b32 v230, 0x10000, v230
    ds_read_b64_tr_b16 v[180:181], v230 offset:16384
    ds_read_b64_tr_b16 v[182:183], v230 offset:16896
    v_mfma_f32_16x16x32_bf16 v[192:195], v[200:203], v[184:187], v[192:195]
    v_mfma_f32_16x16x32_bf16 v[196:199], v[200:203], v[188:191], v[196:199]
    s_waitcnt lgkmcnt(7)
    v_mfma_f32_32x32x16_bf16 v[144:159], v[240:243], v[84:87], v[144:159]
    v_xor_b32 v224, 0x10000, v224
    ds_read_b128 v[92:95], v224 offset:0
    v_xor_b32 v231, 0x10000, v231
    ds_read_b64_tr_b16 v[184:185], v231 offset:16384
    ds_read_b64_tr_b16 v[186:187], v231 offset:16896
    s_waitcnt lgkmcnt(8)
    v_mfma_f32_32x32x16_bf16 v[160:175], v[244:247], v[84:87], v[160:175]
    v_xor_b32 v232, 0x10000, v232
    ds_read_b64_tr_b16 v[188:189], v232 offset:16384
    ds_read_b64_tr_b16 v[190:191], v232 offset:16896
    s_waitcnt lgkmcnt(7)
    v_mfma_f32_32x32x16_bf16 v[144:159], v[176:179], v[88:91], v[144:159]
    s_waitcnt lgkmcnt(0)
    s_barrier
    ds_read_b128 v[96:99], v221 offset:32768
PAD3:
    s_cbranch_execz SC_BACK
QAD1:
    s_cbranch_execz QAD5
    ds_read_b64_tr_b16 v[240:241], v225 offset:49152
    ds_read_b64_tr_b16 v[242:243], v225 offset:49664
    s_xor_b32 s70, s3, 1
    s_mul_i32 s70, s70, 229376
    s_add_u32 s70, s70, s99
    v_mfma_f32_32x32x16_bf16 v[160:175], v[180:183], v[88:91], v[160:175]
    ds_read_b64_tr_b16 v[244:245], v226 offset:49152
    ds_read_b64_tr_b16 v[246:247], v226 offset:49664
    buffer_load_dword v3, off, s[32:35], 0 sc1
    v_mfma_f32_32x32x16_bf16 v[144:159], v[184:187], v[92:95], v[144:159]
    ds_read_b128 v[100:103], v222 offset:32768
    ds_read_b64_tr_b16 v[176:177], v227 offset:49152
    ds_read_b64_tr_b16 v[178:179], v227 offset:49664
    s_cmp_ge_u32 s76, 0x1000000
    s_cbranch_scc1 NOU0_2
    s_xor_b32 m0, s71, 155648
    s_add_u32 s67, s47, 8192
    buffer_load_dwordx4 v220, s[20:23], s47 offen nt lds
    s_xor_b32 m0, s71, 156672
    s_nop 0
    buffer_load_dwordx4 v220, s[20:23], s67 offen nt lds
NOU0_2:
    v_mfma_f32_32x32x16_bf16 v[160:175], v[188:191], v[92:95], v[160:175]
    ds_read_b64_tr_b16 v[180:181], v228 offset:49152
    ds_read_b64_tr_b16 v[182:183], v228 offset:49664
    s_waitcnt lgkmcnt(7)
    v_mfma_f32_32x32x16_bf16 v[144:159], v[240:243], v[96:99], v[144:159]
    ds_read_b128 v[104:107], v223 offset:32768
    ds_read_b64_tr_b16 v[184:185], v229 offset:49152
    ds_read_b64_tr_b16 v[186:187], v229 offset:49664
    s_waitcnt lgkmcnt(8)
    v_mfma_f32_32x32x16_bf16 v[160:175], v[244:247], v[96:99], v[160:175]
    ds_read_b64_tr_b16 v[188:189], v230 offset:49152
    ds_read_b64_tr_b16 v[190:191], v230 offset:49664
    v_mfma_f32_16x16x32_bf16 v[192:195], v[200:203], v[240:243], v[192:195]
    v_mfma_f32_16x16x32_bf16 v[196:199], v[200:203], v[244:247], v[196:199]
    s_waitcnt lgkmcnt(7)
    v_mfma_f32_32x32x16_bf16 v[144:159], v[176:179], v[100:103], v[144:159]
    ds_read_b128 v[108:111], v224 offset:32768
    ds_read_b64_tr_b16 v[240:241], v231 offset:49152
    ds_read_b64_tr_b16 v[242:243], v231 offset:49664
    s_waitcnt lgkmcnt(8)
    v_mfma_f32_32x32x16_bf16 v[160:175], v[180:183], v[100:103], v[160:175]
    ds_read_b64_tr_b16 v[244:245], v232 offset:49152
    ds_read_b64_tr_b16 v[246:247], v232 offset:49664
    s_waitcnt lgkmcnt(7)
    v_mfma_f32_32x32x16_bf16 v[144:159], v[184:187], v[104:107], v[144:159]
    s_waitcnt lgkmcnt(0)
    s_barrier
    v_xor_b32 v221, 0x10000, v221
    ds_read_b128 v[112:115], v221 offset:0
    v_xor_b32 v225, 0x10000, v225
    ds_read_b64_tr_b16 v[176:177], v225 offset:16384
    ds_read_b64_tr_b16 v[178:179], v225 offset:16896
    s_xor_b32 s70, s3, 2
    s_mul_i32 s70, s70, 229376
    s_add_u32 s70, s70, s99
    v_mfma_f32_32x32x16_bf16 v[160:175], v[188:191], v[104:107], v[160:175]
    v_xor_b32 v226, 0x10000, v226
    ds_read_b64_tr_b16 v[180:181], v226 offset:16384
    ds_read_b64_tr_b16 v[182:183], v226 offset:16896
    v_mfma_f32_32x32x16_bf16 v[144:159], v[240:243], v[108:111], v[144:159]
    v_xor_b32 v222, 0x10000, v222
    ds_read_b128 v[116:119], v222 offset:0
    v_xor_b32 v227, 0x10000, v227
    ds_read_b64_tr_b16 v[184:185], v227 offset:16384
    ds_read_b64_tr_b16 v[186:187], v227 offset:16896
    v_mfma_f32_32x32x16_bf16 v[160:175], v[244:247], v[108:111], v[160:175]
    v_xor_b32 v228, 0x10000, v228
    ds_read_b64_tr_b16 v[188:189], v228 offset:16384
    ds_read_b64_tr_b16 v[190:191], v228 offset:16896
    s_waitcnt lgkmcnt(7)
    v_mfma_f32_32x32x16_bf16 v[144:159], v[176:179], v[112:115], v[144:159]
    v_xor_b32 v223, 0x10000, v223
    ds_read_b128 v[120:123], v223 offset:0
    v_xor_b32 v229, 0x10000, v229
    ds_read_b64_tr_b16 v[240:241], v229 offset:16384
    ds_read_b64_tr_b16 v[242:243], v229 offset:16896
    s_waitcnt lgkmcnt(8)
    v_mfma_f32_32x32x16_bf16 v[160:175], v[180:183], v[112:115], v[160:175]
    v_xor_b32 v230, 0x10000, v230
    ds_read_b64_tr_b16 v[244:245], v230 offset:16384
    ds_read_b64_tr_b16 v[246:247], v230 offset:16896
    v_mfma_f32_16x16x32_bf16 v[192:195], v[200:203], v[176:179], v[192:195]
    v_mfma_f32_16x16x32_bf16 v[196:199], v[200:203], v[180:183], v[196:199]
    s_waitcnt lgkmcnt(7)
    v_mfma_f32_32x32x16_bf16 v[144:159], v[184:187], v[116:119], v[144:159]
    v_xor_b32 v224, 0x10000, v224
    ds_read_b128 v[124:127], v224 offset:0
    v_xor_b32 v231, 0x10000, v231
    ds_read_b64_tr_b16 v[176:177], v231 offset:16384
    ds_read_b64_tr_b16 v[178:179], v231 offset:16896
    s_waitcnt lgkmcnt(8)
    v_mfma_f32_32x32x16_bf16 v[160:175], v[188:191], v[116:119], v[160:175]
    v_xor_b32 v232, 0x10000, v232
    ds_read_b64_tr_b16 v[180:181], v232 offset:16384
    ds_read_b64_tr_b16 v[182:183], v232 offset:16896
    s_waitcnt lgkmcnt(7)
    v_mfma_f32_32x32x16_bf16 v[144:159], v[240:243], v[120:123], v[144:159]
    s_waitcnt lgkmcnt(0)
    s_barrier
    ds_read_b128 v[128:131], v221 offset:32768
    ds_read_b64_tr_b16 v[184:185], v225 offset:49152
    ds_read_b64_tr_b16 v[186:187], v225 offset:49664
    s_xor_b32 s70, s3, 3
    s_mul_i32 s70, s70, 229376
    s_add_u32 s70, s70, s99
    v_mfma_f32_32x32x16_bf16 v[160:175], v[244:247], v[120:123], v[160:175]
    ds_read_b64_tr_b16 v[188:189], v226 offset:49152
    ds_read_b64_tr_b16 v[190:191], v226 offset:49664
    ds_read_b128 v[132:135], v222 offset:32768
    ds_read_b128 v[136:139], v223 offset:32768
    ds_read_b128 v[140:143], v224 offset:32768
    buffer_load_ushort v234, v235, s[24:27], 0 offen offset:0
    buffer_load_ushort v235, v235, s[24:27], 0 offen offset:64
    v_mfma_f32_32x32x16_bf16 v[144:159], v[176:179], v[124:127], v[144:159]
    ds_read_b64_tr_b16 v[240:241], v227 offset:49152
    ds_read_b64_tr_b16 v[242:243], v227 offset:49664
    v_mfma_f32_32x32x16_bf16 v[160:175], v[180:183], v[124:127], v[160:175]
    ds_read_b64_tr_b16 v[244:245], v228 offset:49152
    ds_read_b64_tr_b16 v[246:247], v228 offset:49664
    s_waitcnt lgkmcnt(9)
    v_mfma_f32_32x32x16_bf16 v[144:159], v[184:187], v[128:131], v[144:159]
    ds_read_b64_tr_b16 v[176:177], v229 offset:49152
    ds_read_b64_tr_b16 v[178:179], v229 offset:49664
    s_waitcnt lgkmcnt(9)
    v_mfma_f32_32x32x16_bf16 v[160:175], v[188:191], v[128:131], v[160:175]
    ds_read_b64_tr_b16 v[180:181], v230 offset:49152
    ds_read_b64_tr_b16 v[182:183], v230 offset:49664
    v_mfma_f32_16x16x32_bf16 v[192:195], v[200:203], v[184:187], v[192:195]
    v_mfma_f32_16x16x32_bf16 v[196:199], v[200:203], v[188:191], v[196:199]
    s_waitcnt lgkmcnt(6)
    v_mfma_f32_32x32x16_bf16 v[144:159], v[240:243], v[132:135], v[144:159]
    ds_read_b64_tr_b16 v[184:185], v231 offset:49152
    ds_read_b64_tr_b16 v[186:187], v231 offset:49664
    s_lshl_b32 s64, s63, 10
    s_add_u32 s64, s64, 157696
    s_waitcnt lgkmcnt(6)
    v_mfma_f32_32x32x16_bf16 v[160:175], v[244:247], v[132:135], v[160:175]
    ds_read_b64_tr_b16 v[188:189], v232 offset:49152
    ds_read_b64_tr_b16 v[190:191], v232 offset:49664
    v_lshl_add_u32 v6, v4, 5, s64
    s_bfe_u32 s64, s77, 0x10006
    s_lshl_b32 s64, s64, 9
    s_bfe_u32 s65, s77, 0x1000d
    s_lshl_b32 s65, s65, 10
    s_add_u32 s64, s64, s65
    s_add_u32 s64, s64, 161792
    v_lshl_add_u32 v7, v4, 4, s64
    s_lshl_b32 s65, s63, 2
    v_add_u32 v208, s65, v7
    ds_write_b32 v208, v192 offset:0
PAD4:
    s_cbranch_execz SC_BACK
    ds_write_b32 v208, v196 offset:512
    s_waitcnt lgkmcnt(6)
    v_mfma_f32_32x32x16_bf16 v[144:159], v[176:179], v[136:139], v[144:159]
    s_waitcnt lgkmcnt(0)
    s_barrier
    ds_read_b64 v[8:9], v6
    ds_read_b128 v[192:195], v7 offset:0
    ds_read_b128 v[196:199], v7 offset:512
    v_xor_b32 v225, 0, v237
    ds_read_b64_tr_b16 v[240:241], v225 offset:0
    ds_read_b64_tr_b16 v[242:243], v225 offset:512
    v_cmp_eq_u32 vcc, 0, v5
    v_mov_b32 v206, 0
    v_mfma_f32_32x32x16_bf16 v[160:175], v[180:183], v[136:139], v[160:175]
    v_xor_b32 v226, 64, v237
    ds_read_b64_tr_b16 v[244:245], v226 offset:0
    ds_read_b64_tr_b16 v[246:247], v226 offset:512
    v_mov_b32 v207, 0
    v_mfma_f32_32x32x16_bf16 v[144:159], v[184:187], v[140:143], v[144:159]
    v_xor_b32 v227, 2048, v237
    ds_read_b64_tr_b16 v[176:177], v227 offset:0
    ds_read_b64_tr_b16 v[178:179], v227 offset:512
    s_waitcnt lgkmcnt(6)
    v_mul_f32 v208, 0x3b000000, v8
    v_add_f32 v192, v192, v193
    v_mul_f32 v209, 0x3b000000, v9
    v_add_f32 v196, v196, v197
    v_fma_f32 v209, -v208, v208, v209
    v_add_f32 v194, v194, v195
    v_max_f32 v209, 0, v209
    v_add_f32 v198, v198, v199
    v_mfma_f32_32x32x16_bf16 v[160:175], v[188:191], v[140:143], v[160:175]
    v_xor_b32 v228, 2112, v237
    ds_read_b64_tr_b16 v[180:181], v228 offset:0
    ds_read_b64_tr_b16 v[182:183], v228 offset:512
    v_cvt_pk_bf16_f32 v209, v209, v209
    v_add_f32 v192, v192, v194
    v_and_b32 v209, s73, v209
    v_add_f32 v196, v196, v198
    v_add_f32 v209, 0x3727c5ac, v209
    v_cvt_pk_bf16_f32 v193, v192, v192
    v_cvt_pk_bf16_f32 v209, v209, v209
    v_cvt_pk_bf16_f32 v197, v196, v196
    v_and_b32 v209, s73, v209
    v_mov_b32 v195, 0
    v_sqrt_f32 v209, v209
    v_mov_b32 v199, 0
    v_cvt_pk_bf16_f32 v208, -v208, -v208
    v_and_b32 v193, s73, v193
    v_cvt_pk_bf16_f32 v209, v209, v209
    v_and_b32 v197, s73, v197
    v_lshrrev_b32 v210, 16, v209
    v_sub_f32 v194, v192, v193
    v_and_b32 v209, s73, v209
    v_sub_f32 v198, v196, v197
    v_cndmask_b32 v204, 0, v208, vcc
    v_cvt_pk_bf16_f32 v192, v193, v194
    v_cndmask_b32 v205, 0, v210, vcc
    v_cvt_pk_bf16_f32 v196, v197, v198
    v_rcp_f32 v233, v209
    v_mov_b32 v193, 0
    v_mov_b32 v197, 0
    v_mov_b32 v194, 0
    v_mov_b32 v198, 0
    s_nop 0
    v_mfma_f32_32x32x16_bf16 v[144:159], v[192:195], v[204:207], v[144:159]
    v_mfma_f32_32x32x16_bf16 v[160:175], v[196:199], v[204:207], v[160:175]
    v_mul_f32 v214, s90, v233
    s_nop 9
    v_mul_f32 v144, v214, v144
    v_mul_f32 v145, v214, v145
    v_mul_f32 v146, v214, v146
    v_mul_f32 v147, v214, v147
    v_mul_f32 v148, v214, v148
    v_mul_f32 v149, v214, v149
    v_mul_f32 v150, v214, v150
    v_mul_f32 v151, v214, v151
    v_cvt_pk_bf16_f32 v144, v144, v145
    v_cvt_pk_bf16_f32 v145, v146, v147
    v_cvt_pk_bf16_f32 v146, v148, v149
    v_cvt_pk_bf16_f32 v147, v150, v151
    s_add_u32 s66, s74, 0x0
    buffer_store_dwordx4 v[144:147], v236, s[16:19], s66 offen sc1
    v_mul_f32 v152, v214, v152
    v_mul_f32 v153, v214, v153
    v_mul_f32 v154, v214, v154
    v_mul_f32 v155, v214, v155
    v_mul_f32 v156, v214, v156
    v_mul_f32 v157, v214, v157
    v_mul_f32 v158, v214, v158
    v_mul_f32 v159, v214, v159
    v_cvt_pk_bf16_f32 v152, v152, v153
    v_cvt_pk_bf16_f32 v153, v154, v155
    v_cvt_pk_bf16_f32 v154, v156, v157
    v_cvt_pk_bf16_f32 v155, v158, v159
    s_add_u32 s66, s74, 0x10000
    buffer_store_dwordx4 v[152:155], v236, s[16:19], s66 offen sc1
    v_mul_f32 v160, v214, v160
    v_mul_f32 v161, v214, v161
    v_mul_f32 v162, v214, v162
    v_mul_f32 v163, v214, v163
    v_mul_f32 v164, v214, v164
    v_mul_f32 v165, v214, v165
    v_mul_f32 v166, v214, v166
    v_mul_f32 v167, v214, v167
    v_cvt_pk_bf16_f32 v160, v160, v161
    v_cvt_pk_bf16_f32 v161, v162, v163
    v_cvt_pk_bf16_f32 v162, v164, v165
    v_cvt_pk_bf16_f32 v163, v166, v167
    s_add_u32 s66, s74, 0x20000
    buffer_store_dwordx4 v[160:163], v236, s[16:19], s66 offen sc1
    v_mul_f32 v168, v214, v168
    v_mul_f32 v169, v214, v169
    v_mul_f32 v170, v214, v170
    v_mul_f32 v171, v214, v171
    v_mul_f32 v172, v214, v172
    v_mul_f32 v173, v214, v173
    v_mul_f32 v174, v214, v174
    v_mul_f32 v175, v214, v175
    v_cvt_pk_bf16_f32 v168, v168, v169
    v_cvt_pk_bf16_f32 v169, v170, v171
    v_cvt_pk_bf16_f32 v170, v172, v173
    v_cvt_pk_bf16_f32 v171, v174, v175
    s_add_u32 s66, s74, 0x30000
    buffer_store_dwordx4 v[168:171], v236, s[16:19], s66 offen sc1
    s_mov_b32 s85, 0
    s_mov_b32 s53, 0
B_2:
    s_waitcnt lgkmcnt(6)
    v_mfma_f32_32x32x16_bf16 v[144:159], v[240:243], v[16:19], 0
    v_xor_b32 v229, 4096, v237
    ds_read_b64_tr_b16 v[184:185], v229 offset:0
    ds_read_b64_tr_b16 v[186:187], v229 offset:512
    s_add_u32 m0, s72, 0x8000
    s_nop 0
    buffer_load_dwordx4 v219, s[12:15], s70 offen lds
    s_waitcnt lgkmcnt(6)
    v_mfma_f32_32x32x16_bf16 v[160:175], v[244:247], v[16:19], 0
    v_xor_b32 v230, 4160, v237
    ds_read_b64_tr_b16 v[188:189], v230 offset:0
    ds_read_b64_tr_b16 v[190:191], v230 offset:512
    v_mfma_f32_16x16x32_bf16 v[192:195], v[200:203], v[240:243], 0
    v_mfma_f32_16x16x32_bf16 v[196:199], v[200:203], v[244:247], 0
    s_waitcnt lgkmcnt(6)
    v_mfma_f32_32x32x16_bf16 v[144:159], v[176:179], v[20:23], v[144:159]
    v_xor_b32 v231, 6144, v237
    ds_read_b64_tr_b16 v[240:241], v231 offset:0
    ds_read_b64_tr_b16 v[242:243], v231 offset:512
    s_add_u32 m0, s72, 0x9f80
    s_nop 0
    buffer_load_dwordx4 v219, s[12:15], s70 offen offset:128 lds
    s_xor_b32 s70, s3, 4
    s_mul_i32 s70, s70, 229376
    s_add_u32 s70, s70, s99
    s_waitcnt lgkmcnt(6)
    v_mfma_f32_32x32x16_bf16 v[160:175], v[180:183], v[20:23], v[160:175]
    v_xor_b32 v232, 6208, v237
    ds_read_b64_tr_b16 v[244:245], v232 offset:0
    ds_read_b64_tr_b16 v[246:247], v232 offset:512
    s_waitcnt lgkmcnt(6)
    v_mfma_f32_32x32x16_bf16 v[144:159], v[184:187], v[24:27], v[144:159]
    s_waitcnt vmcnt(10)
    s_barrier
    v_xor_b32 v225, 0x20000, v225
    ds_read_b64_tr_b16 v[176:177], v225 offset:0
    ds_read_b64_tr_b16 v[178:179], v225 offset:512
    s_waitcnt lgkmcnt(6)
    v_mfma_f32_32x32x16_bf16 v[160:175], v[188:191], v[24:27], v[160:175]
    v_xor_b32 v226, 0x20000, v226
    ds_read_b64_tr_b16 v[180:181], v226 offset:0
    ds_read_b64_tr_b16 v[182:183], v226 offset:512
    s_waitcnt lgkmcnt(6)
    v_mfma_f32_32x32x16_bf16 v[144:159], v[240:243], v[28:31], v[144:159]
    v_xor_b32 v227, 0x20000, v227
    ds_read_b64_tr_b16 v[184:185], v227 offset:0
    ds_read_b64_tr_b16 v[186:187], v227 offset:512
    s_add_u32 m0, s72, 0xc000
    s_nop 0
    buffer_load_dwordx4 v219, s[12:15], s70 offen lds
PAD5:
    s_cbranch_execz SC_BACK
    s_waitcnt lgkmcnt(6)
    v_mfma_f32_32x32x16_bf16 v[160:175], v[244:247], v[28:31], v[160:175]
    v_xor_b32 v228, 0x20000, v228
    ds_read_b64_tr_b16 v[188:189], v228 offset:0
    ds_read_b64_tr_b16 v[190:191], v228 offset:512
    s_waitcnt lgkmcnt(6)
    v_mfma_f32_32x32x16_bf16 v[144:159], v[176:179], v[32:35], v[144:159]
    v_xor_b32 v229, 0x20000, v229
    ds_read_b64_tr_b16 v[240:241], v229 offset:0
    ds_read_b64_tr_b16 v[242:243], v229 offset:512
    s_add_u32 m0, s72, 0xdf80
    s_nop 0
    buffer_load_dwordx4 v219, s[12:15], s70 offen offset:128 lds
    s_xor_b32 s70, s3, 5
    s_mul_i32 s70, s70, 229376
    s_add_u32 s70, s70, s99
    s_waitcnt lgkmcnt(6)
    v_mfma_f32_32x32x16_bf16 v[160:175], v[180:183], v[32:35], v[160:175]
    v_xor_b32 v230, 0x20000, v230
    ds_read_b64_tr_b16 v[244:245], v230 offset:0
    ds_read_b64_tr_b16 v[246:247], v230 offset:512
    v_mfma_f32_16x16x32_bf16 v[192:195], v[200:203], v[176:179], v[192:195]
    v_mfma_f32_16x16x32_bf16 v[196:199], v[200:203], v[180:183], v[196:199]
    s_waitcnt lgkmcnt(6)
    v_mfma_f32_32x32x16_bf16 v[144:159], v[184:187], v[36:39], v[144:159]
    v_xor_b32 v231, 0x20000, v231
    ds_read_b64_tr_b16 v[176:177], v231 offset:0
    ds_read_b64_tr_b16 v[178:179], v231 offset:512
    s_waitcnt lgkmcnt(6)
    v_mfma_f32_32x32x16_bf16 v[160:175], v[188:191], v[36:39], v[160:175]
    v_xor_b32 v232, 0x20000, v232
    ds_read_b64_tr_b16 v[180:181], v232 offset:0
    ds_read_b64_tr_b16 v[182:183], v232 offset:512
    s_waitcnt lgkmcnt(6)
    v_mfma_f32_32x32x16_bf16 v[144:159], v[240:243], v[40:43], v[144:159]
    s_waitcnt vmcnt(4)
    v_readfirstlane_b32 s44, v3
    s_barrier
    s_cmp_lg_u32 s44, 0
    s_cbranch_scc1 EPOK_2
    s_mov_b32 s95, 4000
EPS_2:
    buffer_load_dword v3, off, s[32:35], 0 sc1
    s_waitcnt vmcnt(0)
    v_readfirstlane_b32 s44, v3
    s_sub_u32 s95, s95, 1
    s_cbranch_scc1 EPOK_2
    s_cmp_eq_u32 s44, 0
    s_cbranch_scc1 EPS_2
EPOK_2:
    s_cmp_lg_u32 s62, 0
    s_cbranch_scc1 PUB_1
    v_mov_b32 v3, s44
    s_mov_b64 exec, 1
    buffer_store_dword v3, off, s[16:19], s45 sc1
    s_mov_b64 exec, -1
PUB_1:
    ds_read_b64_tr_b16 v[184:185], v225 offset:16384
    ds_read_b64_tr_b16 v[186:187], v225 offset:16896
    s_add_u32 m0, s72, 0x10000
    s_nop 0
    buffer_load_dwordx4 v219, s[12:15], s70 offen lds
    s_waitcnt lgkmcnt(6)
    v_mfma_f32_32x32x16_bf16 v[160:175], v[244:247], v[40:43], v[160:175]
    ds_read_b64_tr_b16 v[188:189], v226 offset:16384
    ds_read_b64_tr_b16 v[190:191], v226 offset:16896
    s_waitcnt lgkmcnt(6)
    v_mfma_f32_32x32x16_bf16 v[144:159], v[176:179], v[44:47], v[144:159]
    s_cmp_ge_u32 s76, 0x1000000
    s_cbranch_scc1 NOU1_2
    v_xor_b32 v212, 64, v238
    ds_read_b64_tr_b16 v[8:9], v238
    ds_read_b64_tr_b16 v[10:11], v238 offset:1024
    ds_read_b64_tr_b16 v[12:13], v212
    ds_read_b64_tr_b16 v[14:15], v212 offset:1024
NOU1_2:
    ds_read_b64_tr_b16 v[240:241], v227 offset:16384
    ds_read_b64_tr_b16 v[242:243], v227 offset:16896
    s_add_u32 m0, s72, 0x11f80
    s_nop 0
    buffer_load_dwordx4 v219, s[12:15], s70 offen offset:128 lds
    s_xor_b32 s70, s3, 6
    s_mul_i32 s70, s70, 229376
    s_add_u32 s70, s70, s99
    s_waitcnt lgkmcnt(6)
    v_mfma_f32_32x32x16_bf16 v[160:175], v[180:183], v[44:47], v[160:175]
    ds_read_b64_tr_b16 v[244:245], v228 offset:16384
    ds_read_b64_tr_b16 v[246:247], v228 offset:16896
    s_waitcnt lgkmcnt(6)
    v_mfma_f32_32x32x16_bf16 v[144:159], v[184:187], v[48:51], v[144:159]
    ds_read_b64_tr_b16 v[176:177], v229 offset:16384
    ds_read_b64_tr_b16 v[178:179], v229 offset:16896
    s_waitcnt lgkmcnt(6)
    v_mfma_f32_32x32x16_bf16 v[160:175], v[188:191], v[48:51], v[160:175]
    ds_read_b64_tr_b16 v[180:181], v230 offset:16384
    ds_read_b64_tr_b16 v[182:183], v230 offset:16896
    v_mfma_f32_16x16x32_bf16 v[192:195], v[200:203], v[184:187], v[192:195]
    v_mfma_f32_16x16x32_bf16 v[196:199], v[200:203], v[188:191], v[196:199]
    s_waitcnt lgkmcnt(6)
    v_mfma_f32_32x32x16_bf16 v[144:159], v[240:243], v[52:55], v[144:159]
    ds_read_b64_tr_b16 v[184:185], v231 offset:16384
    ds_read_b64_tr_b16 v[186:187], v231 offset:16896
    s_add_u32 m0, s72, 0x14000
    s_nop 0
    buffer_load_dwordx4 v219, s[12:15], s70 offen lds
    s_waitcnt lgkmcnt(6)
    v_mfma_f32_32x32x16_bf16 v[160:175], v[244:247], v[52:55], v[160:175]
    ds_read_b64_tr_b16 v[188:189], v232 offset:16384
    ds_read_b64_tr_b16 v[190:191], v232 offset:16896
    s_waitcnt lgkmcnt(6)
    v_mfma_f32_32x32x16_bf16 v[144:159], v[176:179], v[56:59], v[144:159]
    s_waitcnt vmcnt(5)
    s_barrier
    s_cmp_ge_u32 s76, 0x1000000
    s_cbranch_scc1 NOU2_2
    buffer_store_dwordx4 v[8:11], v2, s[16:19], s76 offen sc1
    buffer_store_dwordx4 v[12:15], v2, s[16:19], s76 offen offset:1024 sc1
NOU2_2:
    ds_read_b64_tr_b16 v[240:241], v225 offset:32768
    ds_read_b64_tr_b16 v[242:243], v225 offset:33280
    s_add_u32 m0, s72, 0x15f80
    s_nop 0
    buffer_load_dwordx4 v219, s[12:15], s70 offen offset:128 lds
    s_xor_b32 s70, s3, 7
    s_mul_i32 s70, s70, 229376
    s_add_u32 s70, s70, s99
    s_waitcnt lgkmcnt(6)
    v_mfma_f32_32x32x16_bf16 v[160:175], v[180:183], v[56:59], v[160:175]
    ds_read_b64_tr_b16 v[244:245], v226 offset:32768
    ds_read_b64_tr_b16 v[246:247], v226 offset:33280
    s_waitcnt lgkmcnt(6)
    v_mfma_f32_32x32x16_bf16 v[144:159], v[184:187], v[60:63], v[144:159]
    ds_read_b64_tr_b16 v[176:177], v227 offset:32768
    ds_read_b64_tr_b16 v[178:179], v227 offset:33280
    s_waitcnt lgkmcnt(6)
    v_mfma_f32_32x32x16_bf16 v[160:175], v[188:191], v[60:63], v[160:175]
    ds_read_b64_tr_b16 v[180:181], v228 offset:32768
    ds_read_b64_tr_b16 v[182:183], v228 offset:33280
    s_waitcnt lgkmcnt(6)
    v_mfma_f32_32x32x16_bf16 v[144:159], v[240:243], v[64:67], v[144:159]
    ds_read_b64_tr_b16 v[184:185], v229 offset:32768
    ds_read_b64_tr_b16 v[186:187], v229 offset:33280
    s_add_u32 m0, s72, 0x1c000
    s_nop 0
    buffer_load_dwordx4 v219, s[12:15], s70 offen lds
    s_waitcnt lgkmcnt(6)
    v_mfma_f32_32x32x16_bf16 v[160:175], v[244:247], v[64:67], v[160:175]
    ds_read_b64_tr_b16 v[188:189], v230 offset:32768
    ds_read_b64_tr_b16 v[190:191], v230 offset:33280
    v_mfma_f32_16x16x32_bf16 v[192:195], v[200:203], v[240:243], v[192:195]
    v_mfma_f32_16x16x32_bf16 v[196:199], v[200:203], v[244:247], v[196:199]
    s_waitcnt lgkmcnt(6)
    v_mfma_f32_32x32x16_bf16 v[144:159], v[176:179], v[68:71], v[144:159]
    ds_read_b64_tr_b16 v[240:241], v231 offset:32768
    ds_read_b64_tr_b16 v[242:243], v231 offset:33280
    s_add_u32 m0, s72, 0x1df80
    s_nop 0
    buffer_load_dwordx4 v219, s[12:15], s70 offen offset:128 lds
    s_xor_b32 s70, s3, 0
    s_mul_i32 s70, s70, 229376
    s_add_u32 s70, s70, s99
    s_waitcnt lgkmcnt(6)
    v_mfma_f32_32x32x16_bf16 v[160:175], v[180:183], v[68:71], v[160:175]
    ds_read_b64_tr_b16 v[244:245], v232 offset:32768
    ds_read_b64_tr_b16 v[246:247], v232 offset:33280
    s_waitcnt lgkmcnt(6)
    v_mfma_f32_32x32x16_bf16 v[144:159], v[184:187], v[72:75], v[144:159]
    s_waitcnt vmcnt(6)
    s_barrier
    ds_read_b64_tr_b16 v[176:177], v225 offset:49152
    ds_read_b64_tr_b16 v[178:179], v225 offset:49664
PAD6:
    s_cbranch_execz SC_BACK
    s_waitcnt lgkmcnt(6)
    v_mfma_f32_32x32x16_bf16 v[160:175], v[188:191], v[72:75], v[160:175]
    ds_read_b64_tr_b16 v[180:181], v226 offset:49152
    ds_read_b64_tr_b16 v[182:183], v226 offset:49664
    s_waitcnt lgkmcnt(6)
    v_mfma_f32_32x32x16_bf16 v[144:159], v[240:243], v[76:79], v[144:159]
    ds_read_b64_tr_b16 v[184:185], v227 offset:49152
    ds_read_b64_tr_b16 v[186:187], v227 offset:49664
    s_waitcnt lgkmcnt(6)
    v_mfma_f32_32x32x16_bf16 v[160:175], v[244:247], v[76:79], v[160:175]
    ds_read_b64_tr_b16 v[188:189], v228 offset:49152
    ds_read_b64_tr_b16 v[190:191], v228 offset:49664
    s_waitcnt lgkmcnt(6)
    v_mfma_f32_32x32x16_bf16 v[144:159], v[176:179], v[80:83], v[144:159]
    ds_read_b64_tr_b16 v[240:241], v229 offset:49152
    ds_read_b64_tr_b16 v[242:243], v229 offset:49664
    s_waitcnt lgkmcnt(6)
    v_mfma_f32_32x32x16_bf16 v[160:175], v[180:183], v[80:83], v[160:175]
    ds_read_b64_tr_b16 v[244:245], v230 offset:49152
    ds_read_b64_tr_b16 v[246:247], v230 offset:49664
    v_mfma_f32_16x16x32_bf16 v[192:195], v[200:203], v[176:179], v[192:195]
    v_mfma_f32_16x16x32_bf16 v[196:199], v[200:203], v[180:183], v[196:199]
    s_waitcnt lgkmcnt(6)
    v_mfma_f32_32x32x16_bf16 v[144:159], v[184:187], v[84:87], v[144:159]
    ds_read_b64_tr_b16 v[176:177], v231 offset:49152
    ds_read_b64_tr_b16 v[178:179], v231 offset:49664
    s_waitcnt lgkmcnt(6)
    v_mfma_f32_32x32x16_bf16 v[160:175], v[188:191], v[84:87], v[160:175]
    ds_read_b64_tr_b16 v[180:181], v232 offset:49152
    ds_read_b64_tr_b16 v[182:183], v232 offset:49664
    s_waitcnt lgkmcnt(6)
    v_mfma_f32_32x32x16_bf16 v[144:159], v[240:243], v[88:91], v[144:159]
    s_waitcnt vmcnt(0) lgkmcnt(0)
    s_barrier
    v_xor_b32 v225, 0x10000, v225
    ds_read_b64_tr_b16 v[184:185], v225 offset:0
    ds_read_b64_tr_b16 v[186:187], v225 offset:512
    buffer_load_dword v3, v239, s[16:19], 0 offen sc1
    v_mul_u32_u24 v6, 2064, v1
    v_mov_b32 v208, 0x3f80
    v_mfma_f32_32x32x16_bf16 v[160:175], v[244:247], v[88:91], v[160:175]
    v_xor_b32 v226, 0x10000, v226
    ds_read_b64_tr_b16 v[188:189], v226 offset:0
    ds_read_b64_tr_b16 v[190:191], v226 offset:512
    v_mov_b32 v209, 0
    v_mov_b32 v210, 0
    v_mov_b32 v211, 0
    v_mfma_f32_32x32x16_bf16 v[144:159], v[176:179], v[92:95], v[144:159]
    ds_read_b64_tr_b16 v[240:241], v225 offset:16384
    ds_read_b64_tr_b16 v[242:243], v225 offset:16896
    s_mov_b64 exec, 0x7fffffff
    ds_write_b128 v6, v[208:211] offset:2048
    s_mov_b64 exec, -1
    ds_write_b32 v253, v209
    v_mfma_f32_32x32x16_bf16 v[160:175], v[180:183], v[92:95], v[160:175]
    ds_read_b64_tr_b16 v[244:245], v226 offset:16384
    ds_read_b64_tr_b16 v[246:247], v226 offset:16896
    s_waitcnt lgkmcnt(8)
    v_mfma_f32_32x32x16_bf16 v[144:159], v[184:187], v[96:99], v[144:159]
    ds_read_b64_tr_b16 v[176:177], v225 offset:49152
    ds_read_b64_tr_b16 v[178:179], v225 offset:49664
    v_mov_b32 v48, 0
    v_mov_b32 v49, 0
    v_mov_b32 v50, 0
    v_mov_b32 v51, 0
    v_mov_b32 v52, 0
    v_mov_b32 v53, 0
    v_mov_b32 v54, 0
    v_mov_b32 v55, 0
    s_waitcnt lgkmcnt(8)
    v_mfma_f32_32x32x16_bf16 v[160:175], v[188:191], v[96:99], v[160:175]
    ds_read_b64_tr_b16 v[180:181], v226 offset:49152
    ds_read_b64_tr_b16 v[182:183], v226 offset:49664
    v_mov_b32 v56, 0
    v_mov_b32 v57, 0
    v_mov_b32 v58, 0
    v_mov_b32 v59, 0
    v_mov_b32 v60, 0
    v_mov_b32 v61, 0
    v_mov_b32 v62, 0
    v_mov_b32 v63, 0
    v_mfma_f32_16x16x32_bf16 v[192:195], v[200:203], v[184:187], v[192:195]
    v_mfma_f32_16x16x32_bf16 v[196:199], v[200:203], v[188:191], v[196:199]
    s_waitcnt lgkmcnt(8)
    v_mfma_f32_32x32x16_bf16 v[144:159], v[240:243], v[112:115], v[144:159]
    v_xor_b32 v227, 0x10000, v227
    ds_read_b64_tr_b16 v[184:185], v227 offset:0
    ds_read_b64_tr_b16 v[186:187], v227 offset:512
    v_mov_b32 v64, 0
    v_mov_b32 v65, 0
    v_mov_b32 v66, 0
    v_mov_b32 v67, 0
    v_mov_b32 v68, 0
    v_mov_b32 v69, 0
    v_mov_b32 v70, 0
    v_mov_b32 v71, 0
    s_waitcnt lgkmcnt(6)
    v_mfma_f32_32x32x16_bf16 v[160:175], v[244:247], v[112:115], v[160:175]
    v_xor_b32 v228, 0x10000, v228
    ds_read_b64_tr_b16 v[188:189], v228 offset:0
    ds_read_b64_tr_b16 v[190:191], v228 offset:512
    v_mov_b32 v72, 0
    v_mov_b32 v73, 0
    v_mov_b32 v74, 0
    v_mov_b32 v75, 0
    v_mov_b32 v76, 0
    v_mov_b32 v77, 0
    v_mov_b32 v78, 0
    v_mov_b32 v79, 0
    v_mfma_f32_16x16x32_bf16 v[192:195], v[200:203], v[240:243], v[192:195]
    v_mfma_f32_16x16x32_bf16 v[196:199], v[200:203], v[244:247], v[196:199]
    s_waitcnt lgkmcnt(6)
    v_mfma_f32_32x32x16_bf16 v[144:159], v[176:179], v[128:131], v[144:159]
    v_xor_b32 v229, 0x10000, v229
    ds_read_b64_tr_b16 v[240:241], v229 offset:0
    ds_read_b64_tr_b16 v[242:243], v229 offset:512
    s_waitcnt lgkmcnt(6)
    v_mfma_f32_32x32x16_bf16 v[160:175], v[180:183], v[128:131], v[160:175]
    v_xor_b32 v230, 0x10000, v230
    ds_read_b64_tr_b16 v[244:245], v230 offset:0
    ds_read_b64_tr_b16 v[246:247], v230 offset:512
    s_waitcnt vmcnt(0)
    v_cmp_ne_u32 vcc, s44, v3
    s_nop 1
    s_cbranch_vccnz RP_3
    s_mov_b32 s85, 16384
    buffer_load_dwordx4 v[8:11], v2, s[16:19], s81 offen sc1
    s_xor_b32 s67, s81, 1024
    buffer_load_dwordx4 v[12:15], v2, s[16:19], s67 offen sc1
    s_branch CK_2
RP_3:
    buffer_load_dword v3, v239, s[16:19], 0 offen sc1
CK_2:
    v_mfma_f32_16x16x32_bf16 v[192:195], v[200:203], v[176:179], v[192:195]
PAD7:
    s_cbranch_execz SC_BACK
QAD2:
    s_cbranch_execz QAD6
    v_mfma_f32_16x16x32_bf16 v[196:199], v[200:203], v[180:183], v[196:199]
    s_waitcnt lgkmcnt(6)
    v_mfma_f32_32x32x16_bf16 v[144:159], v[184:187], v[100:103], v[144:159]
    v_xor_b32 v231, 0x10000, v231
    ds_read_b64_tr_b16 v[176:177], v231 offset:0
    ds_read_b64_tr_b16 v[178:179], v231 offset:512
    s_waitcnt lgkmcnt(6)
    v_mfma_f32_32x32x16_bf16 v[160:175], v[188:191], v[100:103], v[160:175]
    v_xor_b32 v232, 0x10000, v232
    ds_read_b64_tr_b16 v[180:181], v232 offset:0
    ds_read_b64_tr_b16 v[182:183], v232 offset:512
    s_cmp_lt_u32 s53, s85
    s_cbranch_scc0 KS_4
    s_mov_b32 m0, s80
    s_xor_b32 s67, s79, s53
    buffer_load_dwordx4 v2, s[16:19], s67 offen sc1 lds
    s_add_u32 s80, s80, 8256
    s_add_u32 s53, s53, 4096
KS_4:
    s_bfe_u32 s64, s78, 0x10006
    s_lshl_b32 s64, s64, 9
    s_bfe_u32 s65, s78, 0x1000d
    s_lshl_b32 s65, s65, 10
    s_add_u32 s64, s64, s65
    s_add_u32 s64, s64, 161792
    v_lshl_add_u32 v7, v4, 4, s64
    s_lshl_b32 s65, s63, 2
    v_add_u32 v212, s65, v7
    ds_write_b32 v212, v192 offset:0
    ds_write_b32 v212, v196 offset:512
    s_waitcnt lgkmcnt(8)
    v_mfma_f32_32x32x16_bf16 v[144:159], v[240:243], v[104:107], v[144:159]
    ds_read_b64_tr_b16 v[184:185], v227 offset:16384
    ds_read_b64_tr_b16 v[186:187], v227 offset:16896
    s_waitcnt lgkmcnt(8)
    v_mfma_f32_32x32x16_bf16 v[160:175], v[244:247], v[104:107], v[160:175]
    ds_read_b64_tr_b16 v[188:189], v228 offset:16384
    ds_read_b64_tr_b16 v[190:191], v228 offset:16896
    s_waitcnt lgkmcnt(8)
    v_mfma_f32_32x32x16_bf16 v[144:159], v[176:179], v[108:111], v[144:159]
    s_waitcnt lgkmcnt(4)
    s_barrier
    ds_read_b128 v[192:195], v7 offset:0
    ds_read_b128 v[196:199], v7 offset:512
    ds_read_b64_tr_b16 v[240:241], v229 offset:16384
    ds_read_b64_tr_b16 v[242:243], v229 offset:16896
    v_mfma_f32_32x32x16_bf16 v[160:175], v[180:183], v[108:111], v[160:175]
    ds_read_b64_tr_b16 v[244:245], v230 offset:16384
    ds_read_b64_tr_b16 v[246:247], v230 offset:16896
    s_cmp_lt_u32 s53, s85
    s_cbranch_scc0 KS_5
    s_mov_b32 m0, s80
    s_xor_b32 s67, s79, s53
    buffer_load_dwordx4 v2, s[16:19], s67 offen sc1 lds
    s_add_u32 s80, s80, 8256
    s_add_u32 s53, s53, 4096
KS_5:
    s_waitcnt lgkmcnt(8)
    v_mfma_f32_32x32x16_bf16 v[144:159], v[184:187], v[116:119], v[144:159]
    ds_read_b64_tr_b16 v[176:177], v231 offset:16384
    ds_read_b64_tr_b16 v[178:179], v231 offset:16896
    s_waitcnt lgkmcnt(6)
    v_add_f32 v192, v192, v193
    v_add_f32 v196, v196, v197
    v_add_f32 v194, v194, v195
    v_add_f32 v198, v198, v199
    v_add_f32 v192, v192, v194
    v_add_f32 v196, v196, v198
    v_cvt_pk_bf16_f32 v193, v192, v192
    v_cvt_pk_bf16_f32 v197, v196, v196
    v_mov_b32 v195, 0
    v_mov_b32 v199, 0
    v_mfma_f32_32x32x16_bf16 v[160:175], v[188:191], v[116:119], v[160:175]
    ds_read_b64_tr_b16 v[180:181], v227 offset:49152
    ds_read_b64_tr_b16 v[182:183], v227 offset:49664
    v_and_b32 v193, s73, v193
    v_and_b32 v197, s73, v197
    v_sub_f32 v194, v192, v193
    v_sub_f32 v198, v196, v197
    v_cvt_pk_bf16_f32 v192, v193, v194
    v_cvt_pk_bf16_f32 v196, v197, v198
    v_mov_b32 v193, v234
    v_mov_b32 v197, v235
    v_mov_b32 v194, 0
    v_mov_b32 v198, 0
    s_cmp_lg_u32 s85, 0
    s_cbranch_scc1 CK_6
    s_waitcnt vmcnt(0)
    v_cmp_ne_u32 vcc, s44, v3
    s_nop 1
    s_cbranch_vccnz RP_7
    s_mov_b32 s85, 16384
    buffer_load_dwordx4 v[8:11], v2, s[16:19], s81 offen sc1
    s_xor_b32 s67, s81, 1024
    buffer_load_dwordx4 v[12:15], v2, s[16:19], s67 offen sc1
    s_branch CK_6
RP_7:
    buffer_load_dword v3, v239, s[16:19], 0 offen sc1
CK_6:
    s_waitcnt lgkmcnt(6)
    v_mfma_f32_32x32x16_bf16 v[144:159], v[240:243], v[120:123], v[144:159]
    ds_read_b64_tr_b16 v[184:185], v229 offset:49152
    ds_read_b64_tr_b16 v[186:187], v229 offset:49664
    s_waitcnt lgkmcnt(6)
    v_mfma_f32_32x32x16_bf16 v[160:175], v[244:247], v[120:123], v[160:175]
    ds_read_b64_tr_b16 v[188:189], v231 offset:49152
    ds_read_b64_tr_b16 v[190:191], v231 offset:49664
    s_cmp_lt_u32 s53, s85
    s_cbranch_scc0 KS_8
    s_mov_b32 m0, s80
    s_xor_b32 s67, s79, s53
    buffer_load_dwordx4 v2, s[16:19], s67 offen sc1 lds
    s_add_u32 s80, s80, 8256
    s_add_u32 s53, s53, 4096
KS_8:
    v_mfma_f32_32x32x16_bf16 v[144:159], v[192:195], v[204:207], v[144:159]
    v_mfma_f32_32x32x16_bf16 v[160:175], v[196:199], v[204:207], v[160:175]
    s_waitcnt lgkmcnt(6)
    v_mfma_f32_32x32x16_bf16 v[144:159], v[176:179], v[124:127], v[144:159]
    ds_read_b64_tr_b16 v[240:241], v232 offset:16384
    ds_read_b64_tr_b16 v[242:243], v232 offset:16896
    s_waitcnt lgkmcnt(6)
    v_mfma_f32_32x32x16_bf16 v[144:159], v[180:183], v[132:135], v[144:159]
    ds_read_b64_tr_b16 v[244:245], v228 offset:49152
    ds_read_b64_tr_b16 v[246:247], v228 offset:49664
    s_waitcnt lgkmcnt(6)
    v_mfma_f32_32x32x16_bf16 v[144:159], v[184:187], v[136:139], v[144:159]
    ds_read_b64_tr_b16 v[176:177], v230 offset:49152
    ds_read_b64_tr_b16 v[178:179], v230 offset:49664
    s_waitcnt lgkmcnt(6)
    v_mfma_f32_32x32x16_bf16 v[144:159], v[188:191], v[140:143], v[144:159]
    ds_read_b64_tr_b16 v[180:181], v232 offset:49152
    ds_read_b64_tr_b16 v[182:183], v232 offset:49664
    s_cmp_lt_u32 s53, s85
    s_cbranch_scc0 KS_9
    s_mov_b32 m0, s80
    s_xor_b32 s67, s79, s53
    buffer_load_dwordx4 v2, s[16:19], s67 offen sc1 lds
    s_add_u32 s80, s80, 8256
    s_add_u32 s53, s53, 4096
KS_9:
    s_waitcnt lgkmcnt(6)
    v_mfma_f32_32x32x16_bf16 v[160:175], v[240:243], v[124:127], v[160:175]
    s_lshr_b32 s64, s92, 1
    s_mul_i32 s64, s64, 4352
    s_add_u32 s64, s64, 0x1520000
    s_mul_i32 s65, s93, 8704
    s_add_u32 s65, s65, 0x1520000
    s_add_u32 s66, s65, 4352
    v_and_b32 v212, 15, v1
    v_lshl_add_u32 v215, v212, 2, s66
    s_mov_b64 exec, 0xffff
    v_lshl_add_u32 v215, v212, 2, s64
    s_mov_b32 exec_lo, 0xffff0000
    v_lshl_add_u32 v215, v212, 2, s65
    s_mov_b64 exec, -1
    s_waitcnt lgkmcnt(4)
    v_mfma_f32_32x32x16_bf16 v[160:175], v[244:247], v[132:135], v[160:175]
    v_mul_f32 v144, v144, |v144|
    v_mul_f32 v145, v145, |v145|
    v_mul_f32 v146, v146, |v146|
    v_mul_f32 v147, v147, |v147|
    v_mul_f32 v148, v148, |v148|
    v_mul_f32 v149, v149, |v149|
    v_mul_f32 v150, v150, |v150|
    v_mul_f32 v151, v151, |v151|
    v_cvt_pk_bf16_f32 v144, v144, v145
    v_cvt_pk_bf16_f32 v145, v146, v147
    v_cvt_pk_bf16_f32 v146, v148, v149
    v_cvt_pk_bf16_f32 v147, v150, v151
    v_pk_max_i16 v144, v144, 0
    v_pk_max_i16 v145, v145, 0
    v_pk_max_i16 v146, v146, 0
PAD8:
    s_cbranch_execz SC_BACK
    v_pk_max_i16 v147, v147, 0
    s_waitcnt lgkmcnt(2)
    v_mfma_f32_32x32x16_bf16 v[160:175], v[176:179], v[136:139], v[160:175]
    buffer_store_dwordx4 v[144:147], v2, s[16:19], s75 offen offset:0 sc1
    v_mul_f32 v152, v152, |v152|
    v_mul_f32 v153, v153, |v153|
    v_mul_f32 v154, v154, |v154|
    v_mul_f32 v155, v155, |v155|
    v_mul_f32 v156, v156, |v156|
    v_mul_f32 v157, v157, |v157|
    v_mul_f32 v158, v158, |v158|
    s_waitcnt lgkmcnt(0)
    v_mfma_f32_32x32x16_bf16 v[160:175], v[180:183], v[140:143], v[160:175]
    v_mul_f32 v159, v159, |v159|
    v_cvt_pk_bf16_f32 v152, v152, v153
    v_cvt_pk_bf16_f32 v153, v154, v155
    v_cvt_pk_bf16_f32 v154, v156, v157
    v_cvt_pk_bf16_f32 v155, v158, v159
    v_pk_max_i16 v152, v152, 0
    v_pk_max_i16 v153, v153, 0
    v_pk_max_i16 v154, v154, 0
    v_pk_max_i16 v155, v155, 0
    buffer_store_dwordx4 v[152:155], v2, s[16:19], s75 offen offset:1024 sc1
    s_cmp_lg_u32 s85, 0
    s_cbranch_scc1 C_RDY_2
    s_mov_b32 s95, 4000
    s_branch C_SPIN_2_P
C_SPIN_2:
    buffer_load_dword v3, v239, s[16:19], 0 offen sc1
C_SPIN_2_P:
    s_sub_u32 s95, s95, 1
    s_waitcnt vmcnt(0)
    v_cmp_ne_u32 vcc, s44, v3
    s_cbranch_scc1 C_SPIN_2_X
    s_nop 0
    s_cbranch_vccnz C_SPIN_2
C_SPIN_2_X:
    buffer_load_dwordx4 v[8:11], v2, s[16:19], s81 offen sc1
    s_xor_b32 s67, s81, 1024
    buffer_load_dwordx4 v[12:15], v2, s[16:19], s67 offen sc1
C_RDY_2:
    s_cmp_ge_u32 s53, 16384
    s_cbranch_scc1 C_KV_2
C_KL_2:
    s_mov_b32 m0, s80
    s_xor_b32 s67, s79, s53
    buffer_load_dwordx4 v2, s[16:19], s67 offen sc1 lds
    s_add_u32 s80, s80, 8256
    s_add_u32 s53, s53, 4096
    s_cmp_lt_u32 s53, 16384
    s_cbranch_scc1 C_KL_2
    s_waitcnt vmcnt(0)
C_KV_2:
    s_waitcnt vmcnt(4) lgkmcnt(0)
    s_barrier
    ds_read_b128 v[176:179], v248
    ds_read_b64_tr_b16 v[180:181], v249
    ds_read_b64_tr_b16 v[182:183], v250
    ds_read_b64_tr_b16 v[184:185], v251
    ds_read_b64_tr_b16 v[186:187], v252
    s_mov_b32 exec_lo, 0x80000000
    ds_write_b128 v6, v[208:211] offset:2048
    s_mov_b32 exec_lo, -1
    v_mul_f32 v214, v233, v233
    v_lshlrev_b32 v7, 2, v4
    v_mul_f32 v160, v160, |v160|
    v_mul_f32 v161, v161, |v161|
    v_mul_f32 v162, v162, |v162|
    v_mul_f32 v163, v163, |v163|
    v_mul_f32 v164, v164, |v164|
    v_mul_f32 v165, v165, |v165|
    v_mul_f32 v166, v166, |v166|
    v_mul_f32 v167, v167, |v167|
    v_cvt_pk_bf16_f32 v160, v160, v161
    v_cvt_pk_bf16_f32 v161, v162, v163
    v_cvt_pk_bf16_f32 v162, v164, v165
    v_cvt_pk_bf16_f32 v163, v166, v167
    v_pk_max_i16 v160, v160, 0
    v_pk_max_i16 v161, v161, 0
    v_pk_max_i16 v162, v162, 0
    v_pk_max_i16 v163, v163, 0
    s_waitcnt lgkmcnt(5)
    v_mfma_f32_32x32x16_bf16 v[16:31], v[176:179], v[8:11], 0
    buffer_store_dwordx4 v[160:163], v2, s[16:19], s75 offen offset:2048 sc1
    v_mul_f32 v168, v168, |v168|
    v_mul_f32 v169, v169, |v169|
    v_mul_f32 v170, v170, |v170|
    v_mul_f32 v171, v171, |v171|
    v_mul_f32 v172, v172, |v172|
    v_mul_f32 v173, v173, |v173|
    v_mul_f32 v174, v174, |v174|
    v_mul_f32 v175, v175, |v175|
    v_cvt_pk_bf16_f32 v168, v168, v169
    v_cvt_pk_bf16_f32 v169, v170, v171
    v_cvt_pk_bf16_f32 v170, v172, v173
    v_cvt_pk_bf16_f32 v171, v174, v175
    v_pk_max_i16 v168, v168, 0
    v_pk_max_i16 v169, v169, 0
    v_pk_max_i16 v170, v170, 0
    v_pk_max_i16 v171, v171, 0
    buffer_store_dwordx4 v[168:171], v2, s[16:19], s75 offen offset:3072 sc1
    s_lshr_b32 s64, s62, 2
    s_or_b32 s64, s64, s91
    s_cmp_lg_u32 s64, 0
    s_cbranch_scc1 NORI_10
    s_lshl_b32 s65, s89, 7
    s_add_u32 s65, s65, 0x1400000
    buffer_store_dword v214, v7, s[16:19], s65 offen sc1
NORI_10:
    s_branch PHC
A_HI:
QAD0:
    s_cbranch_execz QAD4
    s_setprio 1
    s_add_u32 m0, s71, 0x6000
    s_sub_u32 s67, s68, 65536
    buffer_load_dwordx4 v216, s[4:7], s67 offen lds
    s_add_u32 m0, s71, 0x8000
    s_nop 0
    buffer_load_dwordx4 v216, s[4:7], s68 offen lds
    s_add_u32 m0, s72, 0xb000
    s_sub_u32 s67, s69, 98304
    buffer_load_dwordx4 v218, s[8:11], s67 offen lds
    s_add_u32 m0, s72, 0xc000
    s_nop 0
    buffer_load_dwordx4 v218, s[8:11], s69 offen lds
    s_add_u32 m0, s71, 0x6400
    s_sub_u32 s67, s68, 65536
    buffer_load_dwordx4 v217, s[4:7], s67 offen lds
    s_add_u32 m0, s71, 0x8400
    s_nop 0
    buffer_load_dwordx4 v217, s[4:7], s68 offen lds
    s_add_u32 m0, s72, 0xd000
    s_sub_u32 s67, s69, 98304
    buffer_load_dwordx4 v213, s[8:11], s67 offen lds
    s_xor_b32 s68, s68, 384
    s_xor_b32 s69, s3, 2
    s_mul_i32 s69, s69, 196608
    s_add_u32 s69, s69, s98
    s_lshl_b32 s77, s63, 10
    s_or_b32 s77, s77, 8192
    v_bfe_u32 v6, v1, 2, 2
    v_lshl_add_u32 v225, v6, 6, s77
    v_bfe_u32 v6, v1, 4, 1
    v_lshl_add_u32 v225, v6, 5, v225
    v_and_b32 v6, 3, v1
    v_lshl_add_u32 v225, v6, 3, v225
    v_lshl_add_u32 v225, v5, 9, v225
    v_xor_b32 v227, 1024, v225
    v_xor_b32 v229, 2048, v225
    v_xor_b32 v231, 3072, v225
    s_barrier
    ds_read_b128 v[16:19], v221 offset:0
    ds_read_b64_tr_b16 v[176:177], v225 offset:16384
    ds_read_b64_tr_b16 v[178:179], v225 offset:16640
    ds_read_b128 v[20:23], v222 offset:0
    ds_read_b64_tr_b16 v[184:185], v227 offset:16384
    ds_read_b64_tr_b16 v[186:187], v227 offset:16640
    s_waitcnt lgkmcnt(3)
    v_mfma_f32_32x32x16_bf16 v[144:159], v[176:179], v[16:19], 0
    ds_read_b128 v[24:27], v223 offset:0
    ds_read_b64_tr_b16 v[240:241], v229 offset:16384
    ds_read_b64_tr_b16 v[242:243], v229 offset:16640
    s_add_u32 m0, s71, 0xe000
PAD9:
    s_cbranch_execz SC_BACK
    s_sub_u32 s67, s68, 65536
    buffer_load_dwordx4 v216, s[4:7], s67 offen lds
    v_mfma_f32_4x4x4_16b_bf16 v[160:163], v[16:17], v[16:17], 0
    v_mfma_f32_4x4x4_16b_bf16 v[164:167], v[18:19], v[18:19], 0
    v_mfma_f32_16x16x32_bf16 v[196:199], v[200:203], v[16:19], 0
    s_add_u32 m0, s71, 0x10000
    s_nop 0
    buffer_load_dwordx4 v216, s[4:7], s68 offen lds
    s_waitcnt lgkmcnt(5)
    v_mfma_f32_4x4x4_16b_bf16 v[160:163], v[20:21], v[20:21], v[160:163]
    v_mfma_f32_4x4x4_16b_bf16 v[164:167], v[22:23], v[22:23], v[164:167]
    v_mfma_f32_16x16x32_bf16 v[196:199], v[200:203], v[20:23], v[196:199]
    s_add_u32 m0, s72, 0x13000
    s_sub_u32 s67, s69, 98304
    buffer_load_dwordx4 v218, s[8:11], s67 offen lds
    s_add_u32 m0, s72, 0x14000
    s_nop 0
    buffer_load_dwordx4 v218, s[8:11], s69 offen lds
    v_mfma_f32_16x16x32_bf16 v[192:195], v[200:203], v[176:179], 0
    s_waitcnt lgkmcnt(3)
    v_mfma_f32_32x32x16_bf16 v[144:159], v[184:187], v[20:23], v[144:159]
    ds_read_b128 v[28:31], v224 offset:0
    ds_read_b64_tr_b16 v[176:177], v231 offset:16384
    ds_read_b64_tr_b16 v[178:179], v231 offset:16640
    s_add_u32 m0, s71, 0xe400
    s_sub_u32 s67, s68, 65536
    buffer_load_dwordx4 v217, s[4:7], s67 offen lds
    s_waitcnt lgkmcnt(5)
    v_mfma_f32_4x4x4_16b_bf16 v[160:163], v[24:25], v[24:25], v[160:163]
    s_add_u32 m0, s71, 0x10400
    s_nop 0
    buffer_load_dwordx4 v217, s[4:7], s68 offen lds
    v_mfma_f32_4x4x4_16b_bf16 v[164:167], v[26:27], v[26:27], v[164:167]
    v_mfma_f32_16x16x32_bf16 v[196:199], v[200:203], v[24:27], v[196:199]
    s_add_u32 m0, s72, 0x15000
    s_sub_u32 s67, s69, 98304
    buffer_load_dwordx4 v213, s[8:11], s67 offen lds
    s_xor_b32 s68, s68, 128
    s_xor_b32 s69, s3, 3
    s_mul_i32 s69, s69, 196608
    s_add_u32 s69, s69, s98
    s_add_u32 m0, s71, 0x16000
    s_sub_u32 s67, s68, 65536
    buffer_load_dwordx4 v216, s[4:7], s67 offen lds
    s_waitcnt lgkmcnt(3)
    v_mfma_f32_32x32x16_bf16 v[144:159], v[240:243], v[24:27], v[144:159]
    s_waitcnt vmcnt(8) lgkmcnt(0)
    s_barrier
    ds_read_b128 v[32:35], v221 offset:32768
    ds_read_b64_tr_b16 v[184:185], v225 offset:49152
    ds_read_b64_tr_b16 v[186:187], v225 offset:49408
    s_add_u32 m0, s71, 0x18000
    s_nop 0
    buffer_load_dwordx4 v216, s[4:7], s68 offen lds
    v_mfma_f32_4x4x4_16b_bf16 v[160:163], v[28:29], v[28:29], v[160:163]
    s_add_u32 m0, s72, 0x1b000
    s_sub_u32 s67, s69, 98304
    buffer_load_dwordx4 v218, s[8:11], s67 offen lds
    v_mfma_f32_4x4x4_16b_bf16 v[164:167], v[30:31], v[30:31], v[164:167]
    v_mfma_f32_16x16x32_bf16 v[196:199], v[200:203], v[28:31], v[196:199]
    s_add_u32 m0, s72, 0x1c000
    s_nop 0
    buffer_load_dwordx4 v218, s[8:11], s69 offen lds
    s_add_u32 m0, s71, 0x16400
    s_sub_u32 s67, s68, 65536
    buffer_load_dwordx4 v217, s[4:7], s67 offen lds
    v_mfma_f32_32x32x16_bf16 v[144:159], v[176:179], v[28:31], v[144:159]
    ds_read_b128 v[36:39], v222 offset:32768
    ds_read_b64_tr_b16 v[240:241], v227 offset:49152
    ds_read_b64_tr_b16 v[242:243], v227 offset:49408
    s_add_u32 m0, s71, 0x18400
    s_nop 0
    buffer_load_dwordx4 v217, s[4:7], s68 offen lds
    s_waitcnt lgkmcnt(5)
    v_mfma_f32_4x4x4_16b_bf16 v[160:163], v[32:33], v[32:33], v[160:163]
    s_add_u32 m0, s72, 0x1d000
    s_sub_u32 s67, s69, 98304
    buffer_load_dwordx4 v213, s[8:11], s67 offen lds
    s_xor_b32 s68, s68, 896
    s_xor_b32 s69, s3, 4
    s_mul_i32 s69, s69, 196608
    s_add_u32 s69, s69, s98
    v_mfma_f32_4x4x4_16b_bf16 v[164:167], v[34:35], v[34:35], v[164:167]
    v_mfma_f32_16x16x32_bf16 v[196:199], v[200:203], v[32:35], v[196:199]
    s_add_u32 m0, s71, 0xffffe000
    s_sub_u32 s67, s68, 65536
    buffer_load_dwordx4 v216, s[4:7], s67 offen lds
    s_add_u32 m0, s71, 0x0
    s_nop 0
    buffer_load_dwordx4 v216, s[4:7], s68 offen lds
    s_waitcnt lgkmcnt(3)
    v_mfma_f32_32x32x16_bf16 v[144:159], v[184:187], v[32:35], v[144:159]
    ds_read_b128 v[40:43], v223 offset:32768
    ds_read_b64_tr_b16 v[176:177], v229 offset:49152
    ds_read_b64_tr_b16 v[178:179], v229 offset:49408
    s_add_u32 m0, s72, 0x3000
    s_sub_u32 s67, s69, 98304
    buffer_load_dwordx4 v218, s[8:11], s67 offen lds
    s_waitcnt lgkmcnt(5)
    v_mfma_f32_4x4x4_16b_bf16 v[160:163], v[36:37], v[36:37], v[160:163]
    s_add_u32 m0, s72, 0x4000
    s_nop 0
    buffer_load_dwordx4 v218, s[8:11], s69 offen lds
    v_mfma_f32_4x4x4_16b_bf16 v[164:167], v[38:39], v[38:39], v[164:167]
    v_mfma_f32_16x16x32_bf16 v[196:199], v[200:203], v[36:39], v[196:199]
    s_add_u32 m0, s71, 0xffffe400
    s_sub_u32 s67, s68, 65536
    buffer_load_dwordx4 v217, s[4:7], s67 offen lds
    s_add_u32 m0, s71, 0x400
    s_nop 0
    buffer_load_dwordx4 v217, s[4:7], s68 offen lds
    v_mfma_f32_16x16x32_bf16 v[192:195], v[200:203], v[184:187], v[192:195]
    s_waitcnt lgkmcnt(3)
    v_mfma_f32_32x32x16_bf16 v[144:159], v[240:243], v[36:39], v[144:159]
    ds_read_b128 v[44:47], v224 offset:32768
    ds_read_b64_tr_b16 v[184:185], v231 offset:49152
    ds_read_b64_tr_b16 v[186:187], v231 offset:49408
    s_add_u32 m0, s72, 0x5000
    s_sub_u32 s67, s69, 98304
    buffer_load_dwordx4 v213, s[8:11], s67 offen lds
    s_xor_b32 s68, s68, 128
    s_xor_b32 s69, s3, 5
    s_mul_i32 s69, s69, 196608
    s_add_u32 s69, s69, s98
    s_waitcnt lgkmcnt(5)
    v_mfma_f32_4x4x4_16b_bf16 v[160:163], v[40:41], v[40:41], v[160:163]
    v_mfma_f32_4x4x4_16b_bf16 v[164:167], v[42:43], v[42:43], v[164:167]
    v_mfma_f32_16x16x32_bf16 v[196:199], v[200:203], v[40:43], v[196:199]
    s_waitcnt lgkmcnt(3)
    v_mfma_f32_32x32x16_bf16 v[144:159], v[176:179], v[40:43], v[144:159]
    s_waitcnt vmcnt(14) lgkmcnt(0)
    s_barrier
    v_xor_b32 v221, 0x10000, v221
    ds_read_b128 v[48:51], v221 offset:0
    v_xor_b32 v225, 0x10000, v225
    ds_read_b64_tr_b16 v[240:241], v225 offset:16384
    ds_read_b64_tr_b16 v[242:243], v225 offset:16640
    v_mfma_f32_4x4x4_16b_bf16 v[160:163], v[44:45], v[44:45], v[160:163]
    v_mfma_f32_4x4x4_16b_bf16 v[164:167], v[46:47], v[46:47], v[164:167]
    v_mfma_f32_16x16x32_bf16 v[196:199], v[200:203], v[44:47], v[196:199]
    v_mfma_f32_32x32x16_bf16 v[144:159], v[184:187], v[44:47], v[144:159]
    v_xor_b32 v222, 0x10000, v222
    ds_read_b128 v[52:55], v222 offset:0
    v_xor_b32 v227, 0x10000, v227
    ds_read_b64_tr_b16 v[176:177], v227 offset:16384
    ds_read_b64_tr_b16 v[178:179], v227 offset:16640
    s_waitcnt lgkmcnt(5)
    v_mfma_f32_4x4x4_16b_bf16 v[160:163], v[48:49], v[48:49], v[160:163]
    v_mfma_f32_4x4x4_16b_bf16 v[164:167], v[50:51], v[50:51], v[164:167]
    v_mfma_f32_16x16x32_bf16 v[196:199], v[200:203], v[48:51], v[196:199]
    s_waitcnt lgkmcnt(3)
PAD10:
    s_cbranch_execz SC_BACK
    v_mfma_f32_32x32x16_bf16 v[144:159], v[240:243], v[48:51], v[144:159]
    v_xor_b32 v223, 0x10000, v223
    ds_read_b128 v[56:59], v223 offset:0
    v_xor_b32 v229, 0x10000, v229
    ds_read_b64_tr_b16 v[184:185], v229 offset:16384
    ds_read_b64_tr_b16 v[186:187], v229 offset:16640
    buffer_store_dwordx4 v[204:207], v2, s[16:19], s58 offen offset:0 sc1
    s_waitcnt lgkmcnt(5)
    v_mfma_f32_4x4x4_16b_bf16 v[160:163], v[52:53], v[52:53], v[160:163]
    buffer_store_dwordx4 v[204:207], v2, s[16:19], s58 offen offset:1024 sc1
    v_mfma_f32_4x4x4_16b_bf16 v[164:167], v[54:55], v[54:55], v[164:167]
    v_mfma_f32_16x16x32_bf16 v[196:199], v[200:203], v[52:55], v[196:199]
    v_mfma_f32_16x16x32_bf16 v[192:195], v[200:203], v[240:243], v[192:195]
    s_waitcnt lgkmcnt(3)
    v_mfma_f32_32x32x16_bf16 v[144:159], v[176:179], v[52:55], v[144:159]
    v_xor_b32 v224, 0x10000, v224
    ds_read_b128 v[60:63], v224 offset:0
    v_xor_b32 v231, 0x10000, v231
    ds_read_b64_tr_b16 v[240:241], v231 offset:16384
    ds_read_b64_tr_b16 v[242:243], v231 offset:16640
    s_waitcnt lgkmcnt(5)
    v_mfma_f32_4x4x4_16b_bf16 v[160:163], v[56:57], v[56:57], v[160:163]
    v_mfma_f32_4x4x4_16b_bf16 v[164:167], v[58:59], v[58:59], v[164:167]
    v_mfma_f32_16x16x32_bf16 v[196:199], v[200:203], v[56:59], v[196:199]
    s_waitcnt lgkmcnt(3)
    v_mfma_f32_32x32x16_bf16 v[144:159], v[184:187], v[56:59], v[144:159]
    s_waitcnt vmcnt(9) lgkmcnt(0)
    s_barrier
    ds_read_b128 v[64:67], v221 offset:32768
    ds_read_b64_tr_b16 v[176:177], v225 offset:49152
    ds_read_b64_tr_b16 v[178:179], v225 offset:49408
    s_add_u32 m0, s71, 0x6000
    s_sub_u32 s67, s68, 65536
    buffer_load_dwordx4 v216, s[4:7], s67 offen lds
    v_mfma_f32_4x4x4_16b_bf16 v[160:163], v[60:61], v[60:61], v[160:163]
    s_add_u32 m0, s71, 0x8000
    s_nop 0
    buffer_load_dwordx4 v216, s[4:7], s68 offen lds
    v_mfma_f32_4x4x4_16b_bf16 v[164:167], v[62:63], v[62:63], v[164:167]
    v_mfma_f32_16x16x32_bf16 v[196:199], v[200:203], v[60:63], v[196:199]
    s_add_u32 m0, s72, 0xb000
    s_sub_u32 s67, s69, 98304
    buffer_load_dwordx4 v218, s[8:11], s67 offen lds
    s_add_u32 m0, s72, 0xc000
    s_nop 0
    buffer_load_dwordx4 v218, s[8:11], s69 offen lds
    v_mfma_f32_32x32x16_bf16 v[144:159], v[240:243], v[60:63], v[144:159]
    ds_read_b128 v[68:71], v222 offset:32768
    ds_read_b64_tr_b16 v[184:185], v227 offset:49152
    ds_read_b64_tr_b16 v[186:187], v227 offset:49408
    s_add_u32 m0, s71, 0x6400
    s_sub_u32 s67, s68, 65536
    buffer_load_dwordx4 v217, s[4:7], s67 offen lds
    s_waitcnt lgkmcnt(5)
    v_mfma_f32_4x4x4_16b_bf16 v[160:163], v[64:65], v[64:65], v[160:163]
    s_add_u32 m0, s71, 0x8400
    s_nop 0
    buffer_load_dwordx4 v217, s[4:7], s68 offen lds
    v_mfma_f32_4x4x4_16b_bf16 v[164:167], v[66:67], v[66:67], v[164:167]
    v_mfma_f32_16x16x32_bf16 v[196:199], v[200:203], v[64:67], v[196:199]
    s_add_u32 m0, s72, 0xd000
    s_sub_u32 s67, s69, 98304
    buffer_load_dwordx4 v213, s[8:11], s67 offen lds
    s_xor_b32 s68, s68, 384
    s_xor_b32 s69, s3, 6
    s_mul_i32 s69, s69, 196608
    s_add_u32 s69, s69, s98
    s_waitcnt lgkmcnt(3)
    v_mfma_f32_32x32x16_bf16 v[144:159], v[176:179], v[64:67], v[144:159]
    ds_read_b128 v[72:75], v223 offset:32768
    ds_read_b64_tr_b16 v[240:241], v229 offset:49152
    ds_read_b64_tr_b16 v[242:243], v229 offset:49408
    s_waitcnt lgkmcnt(5)
    v_mfma_f32_4x4x4_16b_bf16 v[160:163], v[68:69], v[68:69], v[160:163]
    v_mfma_f32_4x4x4_16b_bf16 v[164:167], v[70:71], v[70:71], v[164:167]
    v_mfma_f32_16x16x32_bf16 v[196:199], v[200:203], v[68:71], v[196:199]
    v_mfma_f32_16x16x32_bf16 v[192:195], v[200:203], v[176:179], v[192:195]
    s_waitcnt lgkmcnt(3)
    v_mfma_f32_32x32x16_bf16 v[144:159], v[184:187], v[68:71], v[144:159]
    ds_read_b128 v[76:79], v224 offset:32768
    ds_read_b64_tr_b16 v[176:177], v231 offset:49152
    ds_read_b64_tr_b16 v[178:179], v231 offset:49408
    s_waitcnt lgkmcnt(5)
    v_mfma_f32_4x4x4_16b_bf16 v[160:163], v[72:73], v[72:73], v[160:163]
    v_mfma_f32_4x4x4_16b_bf16 v[164:167], v[74:75], v[74:75], v[164:167]
    v_mfma_f32_16x16x32_bf16 v[196:199], v[200:203], v[72:75], v[196:199]
    s_waitcnt lgkmcnt(3)
    v_mfma_f32_32x32x16_bf16 v[144:159], v[240:243], v[72:75], v[144:159]
    s_waitcnt vmcnt(9) lgkmcnt(0)
    s_barrier
    v_xor_b32 v221, 0x10000, v221
    ds_read_b128 v[80:83], v221 offset:0
    v_xor_b32 v225, 0x10000, v225
    ds_read_b64_tr_b16 v[184:185], v225 offset:16384
    ds_read_b64_tr_b16 v[186:187], v225 offset:16640
    s_add_u32 m0, s71, 0xe000
    s_sub_u32 s67, s68, 65536
    buffer_load_dwordx4 v216, s[4:7], s67 offen lds
    v_mfma_f32_4x4x4_16b_bf16 v[160:163], v[76:77], v[76:77], v[160:163]
    s_add_u32 m0, s71, 0x10000
    s_nop 0
    buffer_load_dwordx4 v216, s[4:7], s68 offen lds
    v_mfma_f32_4x4x4_16b_bf16 v[164:167], v[78:79], v[78:79], v[164:167]
    v_mfma_f32_16x16x32_bf16 v[196:199], v[200:203], v[76:79], v[196:199]
    s_add_u32 m0, s72, 0x13000
    s_sub_u32 s67, s69, 98304
    buffer_load_dwordx4 v218, s[8:11], s67 offen lds
    s_add_u32 m0, s72, 0x14000
    s_nop 0
    buffer_load_dwordx4 v218, s[8:11], s69 offen lds
    v_mfma_f32_32x32x16_bf16 v[144:159], v[176:179], v[76:79], v[144:159]
    v_xor_b32 v222, 0x10000, v222
    ds_read_b128 v[84:87], v222 offset:0
    v_xor_b32 v227, 0x10000, v227
PAD11:
    s_cbranch_execz SC_BACK
QAD3:
    s_cbranch_execz QAD7
    ds_read_b64_tr_b16 v[240:241], v227 offset:16384
    ds_read_b64_tr_b16 v[242:243], v227 offset:16640
    s_add_u32 m0, s71, 0xe400
    s_sub_u32 s67, s68, 65536
    buffer_load_dwordx4 v217, s[4:7], s67 offen lds
    s_waitcnt lgkmcnt(5)
    v_mfma_f32_4x4x4_16b_bf16 v[160:163], v[80:81], v[80:81], v[160:163]
    s_add_u32 m0, s71, 0x10400
    s_nop 0
    buffer_load_dwordx4 v217, s[4:7], s68 offen lds
    v_mfma_f32_4x4x4_16b_bf16 v[164:167], v[82:83], v[82:83], v[164:167]
    v_mfma_f32_16x16x32_bf16 v[196:199], v[200:203], v[80:83], v[196:199]
    s_add_u32 m0, s72, 0x15000
    s_sub_u32 s67, s69, 98304
    buffer_load_dwordx4 v213, s[8:11], s67 offen lds
    s_xor_b32 s68, s68, 128
    s_xor_b32 s69, s3, 7
    s_mul_i32 s69, s69, 196608
    s_add_u32 s69, s69, s98
    s_waitcnt lgkmcnt(3)
    v_mfma_f32_32x32x16_bf16 v[144:159], v[184:187], v[80:83], v[144:159]
    v_xor_b32 v223, 0x10000, v223
    ds_read_b128 v[88:91], v223 offset:0
    v_xor_b32 v229, 0x10000, v229
    ds_read_b64_tr_b16 v[176:177], v229 offset:16384
    ds_read_b64_tr_b16 v[178:179], v229 offset:16640
    s_waitcnt lgkmcnt(5)
    v_mfma_f32_4x4x4_16b_bf16 v[160:163], v[84:85], v[84:85], v[160:163]
    v_mfma_f32_4x4x4_16b_bf16 v[164:167], v[86:87], v[86:87], v[164:167]
    v_mfma_f32_16x16x32_bf16 v[196:199], v[200:203], v[84:87], v[196:199]
    v_mfma_f32_16x16x32_bf16 v[192:195], v[200:203], v[184:187], v[192:195]
    s_waitcnt lgkmcnt(3)
    v_mfma_f32_32x32x16_bf16 v[144:159], v[240:243], v[84:87], v[144:159]
    v_xor_b32 v224, 0x10000, v224
    ds_read_b128 v[92:95], v224 offset:0
    v_xor_b32 v231, 0x10000, v231
    ds_read_b64_tr_b16 v[184:185], v231 offset:16384
    ds_read_b64_tr_b16 v[186:187], v231 offset:16640
    s_add_u32 m0, s71, 0x16000
    s_sub_u32 s67, s68, 65536
    buffer_load_dwordx4 v216, s[4:7], s67 offen lds
    s_waitcnt lgkmcnt(5)
    v_mfma_f32_4x4x4_16b_bf16 v[160:163], v[88:89], v[88:89], v[160:163]
    s_add_u32 m0, s71, 0x18000
    s_nop 0
    buffer_load_dwordx4 v216, s[4:7], s68 offen lds
    v_mfma_f32_4x4x4_16b_bf16 v[164:167], v[90:91], v[90:91], v[164:167]
    v_mfma_f32_16x16x32_bf16 v[196:199], v[200:203], v[88:91], v[196:199]
    s_add_u32 m0, s72, 0x1b000
    s_sub_u32 s67, s69, 98304
    buffer_load_dwordx4 v218, s[8:11], s67 offen lds
    s_add_u32 m0, s72, 0x1c000
    s_nop 0
    buffer_load_dwordx4 v218, s[8:11], s69 offen lds
    s_waitcnt lgkmcnt(3)
    v_mfma_f32_32x32x16_bf16 v[144:159], v[176:179], v[88:91], v[144:159]
    s_waitcnt vmcnt(11) lgkmcnt(0)
    s_barrier
    ds_read_b128 v[96:99], v221 offset:32768
    ds_read_b64_tr_b16 v[240:241], v225 offset:49152
    ds_read_b64_tr_b16 v[242:243], v225 offset:49408
    s_add_u32 m0, s71, 0x16400
    s_sub_u32 s67, s68, 65536
    buffer_load_dwordx4 v217, s[4:7], s67 offen lds
    v_mfma_f32_4x4x4_16b_bf16 v[160:163], v[92:93], v[92:93], v[160:163]
    s_add_u32 m0, s71, 0x18400
    s_nop 0
    buffer_load_dwordx4 v217, s[4:7], s68 offen lds
    v_mfma_f32_4x4x4_16b_bf16 v[164:167], v[94:95], v[94:95], v[164:167]
    v_mfma_f32_16x16x32_bf16 v[196:199], v[200:203], v[92:95], v[196:199]
    s_add_u32 m0, s72, 0x1d000
    s_sub_u32 s67, s69, 98304
    buffer_load_dwordx4 v213, s[8:11], s67 offen lds
    s_xor_b32 s68, s68, 896
    s_xor_b32 s69, s3, 0
    s_mul_i32 s69, s69, 196608
    s_add_u32 s69, s69, s98
    v_mfma_f32_32x32x16_bf16 v[144:159], v[184:187], v[92:95], v[144:159]
    ds_read_b128 v[100:103], v222 offset:32768
    ds_read_b64_tr_b16 v[176:177], v227 offset:49152
    ds_read_b64_tr_b16 v[178:179], v227 offset:49408
    s_add_u32 m0, s72, 0x1f000
    s_sub_u32 s67, s70, 114688
    buffer_load_dwordx4 v219, s[12:15], s67 offen lds
    s_waitcnt lgkmcnt(5)
    v_mfma_f32_4x4x4_16b_bf16 v[160:163], v[96:97], v[96:97], v[160:163]
    s_add_u32 m0, s72, 0x20000
    s_nop 0
    buffer_load_dwordx4 v219, s[12:15], s70 offen lds
    v_mfma_f32_4x4x4_16b_bf16 v[164:167], v[98:99], v[98:99], v[164:167]
    v_mfma_f32_16x16x32_bf16 v[196:199], v[200:203], v[96:99], v[196:199]
    s_waitcnt lgkmcnt(3)
    v_mfma_f32_32x32x16_bf16 v[144:159], v[240:243], v[96:99], v[144:159]
    ds_read_b128 v[104:107], v223 offset:32768
    ds_read_b64_tr_b16 v[184:185], v229 offset:49152
    ds_read_b64_tr_b16 v[186:187], v229 offset:49408
    s_add_u32 m0, s72, 0x20f80
    s_sub_u32 s67, s70, 114688
    buffer_load_dwordx4 v219, s[12:15], s67 offen offset:128 lds
    s_waitcnt lgkmcnt(5)
    v_mfma_f32_4x4x4_16b_bf16 v[160:163], v[100:101], v[100:101], v[160:163]
    s_add_u32 m0, s72, 0x21f80
    s_nop 0
    buffer_load_dwordx4 v219, s[12:15], s70 offen offset:128 lds
    s_xor_b32 s70, s3, 1
    s_mul_i32 s70, s70, 229376
    s_add_u32 s70, s70, s99
    v_mfma_f32_4x4x4_16b_bf16 v[164:167], v[102:103], v[102:103], v[164:167]
    v_mfma_f32_16x16x32_bf16 v[196:199], v[200:203], v[100:103], v[196:199]
    v_mfma_f32_16x16x32_bf16 v[192:195], v[200:203], v[240:243], v[192:195]
    s_waitcnt lgkmcnt(3)
    v_mfma_f32_32x32x16_bf16 v[144:159], v[176:179], v[100:103], v[144:159]
    ds_read_b128 v[108:111], v224 offset:32768
    ds_read_b64_tr_b16 v[240:241], v231 offset:49152
    ds_read_b64_tr_b16 v[242:243], v231 offset:49408
    buffer_load_dword v3, off, s[32:35], 0 sc1
    s_cmp_ge_u32 s76, 0x1000000
    s_cbranch_scc1 NOU0_1
    s_xor_b32 m0, s71, 155648
    s_add_u32 s67, s47, 8192
    buffer_load_dwordx4 v220, s[20:23], s47 offen nt lds
    s_xor_b32 m0, s71, 156672
    s_nop 0
    buffer_load_dwordx4 v220, s[20:23], s67 offen nt lds
NOU0_1:
    s_waitcnt lgkmcnt(5)
    v_mfma_f32_4x4x4_16b_bf16 v[160:163], v[104:105], v[104:105], v[160:163]
    v_mfma_f32_4x4x4_16b_bf16 v[164:167], v[106:107], v[106:107], v[164:167]
    v_mfma_f32_16x16x32_bf16 v[196:199], v[200:203], v[104:107], v[196:199]
    s_waitcnt lgkmcnt(3)
    v_mfma_f32_32x32x16_bf16 v[144:159], v[184:187], v[104:107], v[144:159]
    s_waitcnt vmcnt(12) lgkmcnt(0)
    s_barrier
    v_xor_b32 v221, 0x10000, v221
    ds_read_b128 v[112:115], v221 offset:0
    v_xor_b32 v225, 0x10000, v225
    ds_read_b64_tr_b16 v[176:177], v225 offset:16384
    ds_read_b64_tr_b16 v[178:179], v225 offset:16640
    s_add_u32 m0, s72, 0xfffff000
    s_sub_u32 s67, s70, 114688
    buffer_load_dwordx4 v219, s[12:15], s67 offen lds
    v_mfma_f32_4x4x4_16b_bf16 v[160:163], v[108:109], v[108:109], v[160:163]
    s_add_u32 m0, s72, 0x0
    s_nop 0
    buffer_load_dwordx4 v219, s[12:15], s70 offen lds
    v_mfma_f32_4x4x4_16b_bf16 v[164:167], v[110:111], v[110:111], v[164:167]
    v_mfma_f32_16x16x32_bf16 v[196:199], v[200:203], v[108:111], v[196:199]
    v_mfma_f32_32x32x16_bf16 v[144:159], v[240:243], v[108:111], v[144:159]
    v_xor_b32 v222, 0x10000, v222
    ds_read_b128 v[116:119], v222 offset:0
    v_xor_b32 v227, 0x10000, v227
    ds_read_b64_tr_b16 v[184:185], v227 offset:16384
PAD12:
    s_cbranch_execz SC_BACK
    ds_read_b64_tr_b16 v[186:187], v227 offset:16640
    s_add_u32 m0, s72, 0xf80
    s_sub_u32 s67, s70, 114688
    buffer_load_dwordx4 v219, s[12:15], s67 offen offset:128 lds
    s_waitcnt lgkmcnt(5)
    v_mfma_f32_4x4x4_16b_bf16 v[160:163], v[112:113], v[112:113], v[160:163]
    s_add_u32 m0, s72, 0x1f80
    s_nop 0
    buffer_load_dwordx4 v219, s[12:15], s70 offen offset:128 lds
    s_xor_b32 s70, s3, 2
    s_mul_i32 s70, s70, 229376
    s_add_u32 s70, s70, s99
    v_mfma_f32_4x4x4_16b_bf16 v[164:167], v[114:115], v[114:115], v[164:167]
    v_mfma_f32_16x16x32_bf16 v[196:199], v[200:203], v[112:115], v[196:199]
    s_waitcnt lgkmcnt(3)
    v_mfma_f32_32x32x16_bf16 v[144:159], v[176:179], v[112:115], v[144:159]
    v_xor_b32 v223, 0x10000, v223
    ds_read_b128 v[120:123], v223 offset:0
    v_xor_b32 v229, 0x10000, v229
    ds_read_b64_tr_b16 v[240:241], v229 offset:16384
    ds_read_b64_tr_b16 v[242:243], v229 offset:16640
    s_waitcnt lgkmcnt(5)
    v_mfma_f32_4x4x4_16b_bf16 v[160:163], v[116:117], v[116:117], v[160:163]
    v_mfma_f32_4x4x4_16b_bf16 v[164:167], v[118:119], v[118:119], v[164:167]
    v_mfma_f32_16x16x32_bf16 v[196:199], v[200:203], v[116:119], v[196:199]
    v_mfma_f32_16x16x32_bf16 v[192:195], v[200:203], v[176:179], v[192:195]
    s_waitcnt lgkmcnt(3)
    v_mfma_f32_32x32x16_bf16 v[144:159], v[184:187], v[116:119], v[144:159]
    v_xor_b32 v224, 0x10000, v224
    ds_read_b128 v[124:127], v224 offset:0
    v_xor_b32 v231, 0x10000, v231
    ds_read_b64_tr_b16 v[176:177], v231 offset:16384
    ds_read_b64_tr_b16 v[178:179], v231 offset:16640
    s_waitcnt lgkmcnt(5)
    v_mfma_f32_4x4x4_16b_bf16 v[160:163], v[120:121], v[120:121], v[160:163]
    v_mfma_f32_4x4x4_16b_bf16 v[164:167], v[122:123], v[122:123], v[164:167]
    v_mfma_f32_16x16x32_bf16 v[196:199], v[200:203], v[120:123], v[196:199]
    s_waitcnt lgkmcnt(3)
    v_mfma_f32_32x32x16_bf16 v[144:159], v[240:243], v[120:123], v[144:159]
    s_waitcnt vmcnt(9) lgkmcnt(0)
    s_barrier
    ds_read_b128 v[128:131], v221 offset:32768
    ds_read_b64_tr_b16 v[184:185], v225 offset:49152
    ds_read_b64_tr_b16 v[186:187], v225 offset:49408
    ds_read_b128 v[132:135], v222 offset:32768
    ds_read_b128 v[136:139], v223 offset:32768
    ds_read_b128 v[140:143], v224 offset:32768
    s_add_u32 m0, s72, 0x3000
    s_sub_u32 s67, s70, 114688
    buffer_load_dwordx4 v219, s[12:15], s67 offen lds
    v_mfma_f32_4x4x4_16b_bf16 v[160:163], v[124:125], v[124:125], v[160:163]
    s_add_u32 m0, s72, 0x4000
    s_nop 0
    buffer_load_dwordx4 v219, s[12:15], s70 offen lds
    v_mfma_f32_4x4x4_16b_bf16 v[164:167], v[126:127], v[126:127], v[164:167]
    v_mfma_f32_16x16x32_bf16 v[196:199], v[200:203], v[124:127], v[196:199]
    v_mfma_f32_32x32x16_bf16 v[144:159], v[176:179], v[124:127], v[144:159]
    ds_read_b64_tr_b16 v[240:241], v227 offset:49152
    ds_read_b64_tr_b16 v[242:243], v227 offset:49408
    s_add_u32 m0, s72, 0x4f80
    s_sub_u32 s67, s70, 114688
    buffer_load_dwordx4 v219, s[12:15], s67 offen offset:128 lds
    s_waitcnt lgkmcnt(7)
    v_mfma_f32_4x4x4_16b_bf16 v[160:163], v[128:129], v[128:129], v[160:163]
    v_mfma_f32_4x4x4_16b_bf16 v[164:167], v[130:131], v[130:131], v[164:167]
    v_mfma_f32_16x16x32_bf16 v[196:199], v[200:203], v[128:131], v[196:199]
    s_add_u32 m0, s72, 0x5f80
    s_nop 0
    buffer_load_dwordx4 v219, s[12:15], s70 offen offset:128 lds
    s_xor_b32 s70, s3, 3
    s_mul_i32 s70, s70, 229376
    s_add_u32 s70, s70, s99
    s_waitcnt lgkmcnt(4)
    v_mfma_f32_4x4x4_16b_bf16 v[160:163], v[132:133], v[132:133], v[160:163]
    v_mfma_f32_4x4x4_16b_bf16 v[164:167], v[134:135], v[134:135], v[164:167]
    v_mfma_f32_16x16x32_bf16 v[196:199], v[200:203], v[132:135], v[196:199]
    v_mfma_f32_32x32x16_bf16 v[144:159], v[184:187], v[128:131], v[144:159]
    ds_read_b64_tr_b16 v[176:177], v229 offset:49152
    ds_read_b64_tr_b16 v[178:179], v229 offset:49408
    buffer_load_ushort v234, v235, s[24:27], 0 offen offset:0
    buffer_load_ushort v235, v235, s[24:27], 0 offen offset:64
    s_waitcnt lgkmcnt(5)
    v_mfma_f32_4x4x4_16b_bf16 v[160:163], v[136:137], v[136:137], v[160:163]
    v_mfma_f32_4x4x4_16b_bf16 v[164:167], v[138:139], v[138:139], v[164:167]
    v_mfma_f32_16x16x32_bf16 v[196:199], v[200:203], v[136:139], v[196:199]
    s_waitcnt lgkmcnt(4)
    v_mfma_f32_4x4x4_16b_bf16 v[160:163], v[140:141], v[140:141], v[160:163]
    v_mfma_f32_4x4x4_16b_bf16 v[164:167], v[142:143], v[142:143], v[164:167]
    v_mfma_f32_16x16x32_bf16 v[196:199], v[200:203], v[140:143], v[196:199]
    v_mfma_f32_16x16x32_bf16 v[192:195], v[200:203], v[184:187], v[192:195]
    s_waitcnt lgkmcnt(2)
    v_mfma_f32_32x32x16_bf16 v[144:159], v[240:243], v[132:135], v[144:159]
    ds_read_b64_tr_b16 v[184:185], v231 offset:49152
    ds_read_b64_tr_b16 v[186:187], v231 offset:49408
    s_lshl_b32 s64, s63, 10
    s_add_u32 s64, s64, 157696
    v_lshl_add_u32 v6, v4, 5, s64
    v_add_f32 v160, v160, v164
    v_add_f32 v161, v161, v165
    v_add_f32 v162, v162, v166
    v_add_f32 v163, v163, v167
    s_mov_b32 vcc_lo, 0xaaaaaaaa
    s_mov_b32 vcc_hi, 0xaaaaaaaa
    v_cndmask_b32 v160, v160, v161, vcc
    v_cndmask_b32 v162, v162, v163, vcc
    s_mov_b32 vcc_lo, 0xcccccccc
    s_mov_b32 vcc_hi, 0xcccccccc
    v_cndmask_b32 v160, v160, v162, vcc
    v_cndmask_b32 v161, v160, v162, vcc
    s_nop 1
    v_permlane32_swap_b32 v160, v161
    v_add_f32 v197, v160, v161
    s_mov_b32 exec_hi, 0
    ds_write_b64 v6, v[196:197]
    s_mov_b32 exec_hi, -1
    s_bfe_u32 s64, s77, 0x10006
    s_lshl_b32 s64, s64, 9
    s_bfe_u32 s65, s77, 0x1000d
    s_lshl_b32 s65, s65, 10
    s_add_u32 s64, s64, s65
    s_add_u32 s64, s64, 161792
    v_lshl_add_u32 v7, v4, 4, s64
    s_lshl_b32 s65, s63, 2
    v_add_u32 v208, s65, v7
    ds_write_b32 v208, v192 offset:0
    s_waitcnt lgkmcnt(2)
    v_mfma_f32_32x32x16_bf16 v[144:159], v[176:179], v[136:139], v[144:159]
    s_waitcnt vmcnt(11) lgkmcnt(0)
    s_barrier
    ds_read_b64 v[8:9], v6
    ds_read_b128 v[192:195], v7 offset:0
    v_xor_b32 v225, 0, v237
    ds_read_b64_tr_b16 v[240:241], v225 offset:0
    ds_read_b64_tr_b16 v[242:243], v225 offset:512
    v_xor_b32 v226, 64, v237
    ds_read_b64_tr_b16 v[244:245], v226 offset:0
    ds_read_b64_tr_b16 v[246:247], v226 offset:512
    v_cmp_eq_u32 vcc, 0, v5
    v_mov_b32 v206, 0
    v_mov_b32 v207, 0
    v_mfma_f32_32x32x16_bf16 v[144:159], v[184:187], v[140:143], v[144:159]
    v_xor_b32 v227, 2048, v237
    ds_read_b64_tr_b16 v[176:177], v227 offset:0
    ds_read_b64_tr_b16 v[178:179], v227 offset:512
    v_xor_b32 v228, 2112, v237
    ds_read_b64_tr_b16 v[180:181], v228 offset:0
    ds_read_b64_tr_b16 v[182:183], v228 offset:512
    s_waitcnt lgkmcnt(8)
    v_mul_f32 v208, 0x3b000000, v8
    v_add_f32 v192, v192, v193
    v_mul_f32 v209, 0x3b000000, v9
    v_add_f32 v194, v194, v195
    v_fma_f32 v209, -v208, v208, v209
    v_add_f32 v192, v192, v194
    v_max_f32 v209, 0, v209
    v_cvt_pk_bf16_f32 v193, v192, v192
    v_cvt_pk_bf16_f32 v209, v209, v209
    v_mov_b32 v195, 0
    v_and_b32 v209, s73, v209
    v_and_b32 v193, s73, v193
    v_add_f32 v209, 0x3727c5ac, v209
    v_sub_f32 v194, v192, v193
    v_cvt_pk_bf16_f32 v209, v209, v209
    v_cvt_pk_bf16_f32 v192, v193, v194
PAD13:
    s_cbranch_execz SC_BACK
    v_and_b32 v209, s73, v209
    v_mov_b32 v193, 0
    v_sqrt_f32 v209, v209
    v_mov_b32 v194, 0
    v_cvt_pk_bf16_f32 v208, -v208, -v208
    v_cvt_pk_bf16_f32 v209, v209, v209
    v_lshrrev_b32 v210, 16, v209
    v_and_b32 v209, s73, v209
    v_cndmask_b32 v204, 0, v208, vcc
    v_cndmask_b32 v205, 0, v210, vcc
    v_rcp_f32 v233, v209
    s_nop 0
    v_mfma_f32_32x32x16_bf16 v[144:159], v[192:195], v[204:207], v[144:159]
    v_mul_f32 v214, s90, v233
    s_nop 10
    v_mul_f32 v144, v214, v144
    v_mul_f32 v145, v214, v145
    v_mul_f32 v146, v214, v146
    v_mul_f32 v147, v214, v147
    v_mul_f32 v148, v214, v148
    v_mul_f32 v149, v214, v149
    v_mul_f32 v150, v214, v150
    v_mul_f32 v151, v214, v151
    v_cvt_pk_bf16_f32 v144, v144, v145
    v_cvt_pk_bf16_f32 v145, v146, v147
    v_cvt_pk_bf16_f32 v146, v148, v149
    v_cvt_pk_bf16_f32 v147, v150, v151
    s_add_u32 s66, s74, 0x0
    buffer_store_dwordx4 v[144:147], v236, s[16:19], s66 offen sc1
    v_mul_f32 v152, v214, v152
    v_mul_f32 v153, v214, v153
    v_mul_f32 v154, v214, v154
    v_mul_f32 v155, v214, v155
    v_mul_f32 v156, v214, v156
    v_mul_f32 v157, v214, v157
    v_mul_f32 v158, v214, v158
    v_mul_f32 v159, v214, v159
    v_cvt_pk_bf16_f32 v152, v152, v153
    v_cvt_pk_bf16_f32 v153, v154, v155
    v_cvt_pk_bf16_f32 v154, v156, v157
    v_cvt_pk_bf16_f32 v155, v158, v159
    s_add_u32 s66, s74, 0x10000
    buffer_store_dwordx4 v[152:155], v236, s[16:19], s66 offen sc1
    s_setprio 0
    s_mov_b32 s85, 0
    s_mov_b32 s53, 0
    s_cmp_eq_u32 s94, 0
    s_cbranch_scc1 B_2
B_1:
    s_waitcnt lgkmcnt(6)
    v_mfma_f32_32x32x16_bf16 v[144:159], v[240:243], v[16:19], 0
    v_xor_b32 v229, 4096, v237
    ds_read_b64_tr_b16 v[184:185], v229 offset:0
    ds_read_b64_tr_b16 v[186:187], v229 offset:512
    s_add_u32 m0, s72, 0x8000
    s_nop 0
    buffer_load_dwordx4 v219, s[12:15], s70 offen lds
    v_mfma_f32_16x16x32_bf16 v[192:195], v[200:203], v[240:243], 0
    s_waitcnt lgkmcnt(4)
    v_mfma_f32_32x32x16_bf16 v[144:159], v[176:179], v[20:23], v[144:159]
    v_xor_b32 v231, 6144, v237
    ds_read_b64_tr_b16 v[240:241], v231 offset:0
    ds_read_b64_tr_b16 v[242:243], v231 offset:512
    s_add_u32 m0, s72, 0x9f80
    s_nop 0
    buffer_load_dwordx4 v219, s[12:15], s70 offen offset:128 lds
    s_xor_b32 s70, s3, 4
    s_mul_i32 s70, s70, 229376
    s_add_u32 s70, s70, s99
    s_waitcnt lgkmcnt(2)
    v_mfma_f32_32x32x16_bf16 v[144:159], v[184:187], v[24:27], v[144:159]
    s_waitcnt vmcnt(10)
    s_barrier
    v_xor_b32 v225, 0x20000, v225
    ds_read_b64_tr_b16 v[176:177], v225 offset:0
    ds_read_b64_tr_b16 v[178:179], v225 offset:512
    s_waitcnt lgkmcnt(2)
    v_mfma_f32_32x32x16_bf16 v[144:159], v[240:243], v[28:31], v[144:159]
    v_xor_b32 v227, 0x20000, v227
    ds_read_b64_tr_b16 v[184:185], v227 offset:0
    ds_read_b64_tr_b16 v[186:187], v227 offset:512
    s_add_u32 m0, s72, 0xc000
    s_nop 0
    buffer_load_dwordx4 v219, s[12:15], s70 offen lds
    s_waitcnt lgkmcnt(2)
    v_mfma_f32_32x32x16_bf16 v[144:159], v[176:179], v[32:35], v[144:159]
    v_xor_b32 v229, 0x20000, v229
    ds_read_b64_tr_b16 v[240:241], v229 offset:0
    ds_read_b64_tr_b16 v[242:243], v229 offset:512
    s_add_u32 m0, s72, 0xdf80
    s_nop 0
    buffer_load_dwordx4 v219, s[12:15], s70 offen offset:128 lds
    s_xor_b32 s70, s3, 5
    s_mul_i32 s70, s70, 229376
    s_add_u32 s70, s70, s99
    v_mfma_f32_16x16x32_bf16 v[192:195], v[200:203], v[176:179], v[192:195]
    s_waitcnt lgkmcnt(2)
    v_mfma_f32_32x32x16_bf16 v[144:159], v[184:187], v[36:39], v[144:159]
    v_xor_b32 v231, 0x20000, v231
    ds_read_b64_tr_b16 v[176:177], v231 offset:0
    ds_read_b64_tr_b16 v[178:179], v231 offset:512
    s_waitcnt lgkmcnt(2)
    v_mfma_f32_32x32x16_bf16 v[144:159], v[240:243], v[40:43], v[144:159]
    s_waitcnt vmcnt(4)
    v_readfirstlane_b32 s44, v3
    s_barrier
    s_cmp_lg_u32 s44, 0
    s_cbranch_scc1 EPOK_1
    s_mov_b32 s95, 4000
EPS_1:
    buffer_load_dword v3, off, s[32:35], 0 sc1
    s_waitcnt vmcnt(0)
    v_readfirstlane_b32 s44, v3
    s_sub_u32 s95, s95, 1
    s_cbranch_scc1 EPOK_1
    s_cmp_eq_u32 s44, 0
    s_cbranch_scc1 EPS_1
EPOK_1:
    s_cmp_lg_u32 s62, 0
    s_cbranch_scc1 PUB_11
    v_mov_b32 v3, s44
    s_mov_b64 exec, 1
    buffer_store_dword v3, off, s[16:19], s45 sc1
    s_mov_b64 exec, -1
PUB_11:
    ds_read_b64_tr_b16 v[184:185], v225 offset:16384
    ds_read_b64_tr_b16 v[186:187], v225 offset:16896
    s_add_u32 m0, s72, 0x10000
    s_nop 0
    buffer_load_dwordx4 v219, s[12:15], s70 offen lds
    s_waitcnt lgkmcnt(2)
    v_mfma_f32_32x32x16_bf16 v[144:159], v[176:179], v[44:47], v[144:159]
    s_cmp_ge_u32 s76, 0x1000000
    s_cbranch_scc1 NOU1_1
    v_xor_b32 v212, 64, v238
    ds_read_b64_tr_b16 v[8:9], v238
    ds_read_b64_tr_b16 v[10:11], v238 offset:1024
    ds_read_b64_tr_b16 v[12:13], v212
    ds_read_b64_tr_b16 v[14:15], v212 offset:1024
NOU1_1:
    ds_read_b64_tr_b16 v[240:241], v227 offset:16384
    ds_read_b64_tr_b16 v[242:243], v227 offset:16896
    s_add_u32 m0, s72, 0x11f80
    s_nop 0
    buffer_load_dwordx4 v219, s[12:15], s70 offen offset:128 lds
    s_xor_b32 s70, s3, 6
    s_mul_i32 s70, s70, 229376
    s_add_u32 s70, s70, s99
    s_waitcnt lgkmcnt(2)
    v_mfma_f32_32x32x16_bf16 v[144:159], v[184:187], v[48:51], v[144:159]
    ds_read_b64_tr_b16 v[176:177], v229 offset:16384
    ds_read_b64_tr_b16 v[178:179], v229 offset:16896
    v_mfma_f32_16x16x32_bf16 v[192:195], v[200:203], v[184:187], v[192:195]
    s_waitcnt lgkmcnt(2)
    v_mfma_f32_32x32x16_bf16 v[144:159], v[240:243], v[52:55], v[144:159]
    ds_read_b64_tr_b16 v[184:185], v231 offset:16384
    ds_read_b64_tr_b16 v[186:187], v231 offset:16896
    s_add_u32 m0, s72, 0x14000
    s_nop 0
    buffer_load_dwordx4 v219, s[12:15], s70 offen lds
    s_waitcnt lgkmcnt(2)
    v_mfma_f32_32x32x16_bf16 v[144:159], v[176:179], v[56:59], v[144:159]
    s_waitcnt vmcnt(5)
    s_barrier
    s_cmp_ge_u32 s76, 0x1000000
    s_cbranch_scc1 NOU2_1
    buffer_store_dwordx4 v[8:11], v2, s[16:19], s76 offen sc1
    buffer_store_dwordx4 v[12:15], v2, s[16:19], s76 offen offset:1024 sc1
NOU2_1:
    ds_read_b64_tr_b16 v[240:241], v225 offset:32768
    ds_read_b64_tr_b16 v[242:243], v225 offset:33280
    s_add_u32 m0, s72, 0x15f80
    s_nop 0
    buffer_load_dwordx4 v219, s[12:15], s70 offen offset:128 lds
    s_xor_b32 s70, s3, 7
    s_mul_i32 s70, s70, 229376
    s_add_u32 s70, s70, s99
    s_waitcnt lgkmcnt(2)
    v_mfma_f32_32x32x16_bf16 v[144:159], v[184:187], v[60:63], v[144:159]
    ds_read_b64_tr_b16 v[176:177], v227 offset:32768
    ds_read_b64_tr_b16 v[178:179], v227 offset:33280
    s_waitcnt lgkmcnt(2)
    v_mfma_f32_32x32x16_bf16 v[144:159], v[240:243], v[64:67], v[144:159]
    ds_read_b64_tr_b16 v[184:185], v229 offset:32768
PAD14:
    s_cbranch_execz SC_BACK
    ds_read_b64_tr_b16 v[186:187], v229 offset:33280
    s_add_u32 m0, s72, 0x1c000
    s_nop 0
    buffer_load_dwordx4 v219, s[12:15], s70 offen lds
    v_mfma_f32_16x16x32_bf16 v[192:195], v[200:203], v[240:243], v[192:195]
    s_waitcnt lgkmcnt(2)
    v_mfma_f32_32x32x16_bf16 v[144:159], v[176:179], v[68:71], v[144:159]
    ds_read_b64_tr_b16 v[240:241], v231 offset:32768
    ds_read_b64_tr_b16 v[242:243], v231 offset:33280
    s_add_u32 m0, s72, 0x1df80
    s_nop 0
    buffer_load_dwordx4 v219, s[12:15], s70 offen offset:128 lds
    s_xor_b32 s70, s3, 0
    s_mul_i32 s70, s70, 229376
    s_add_u32 s70, s70, s99
    s_waitcnt lgkmcnt(2)
    v_mfma_f32_32x32x16_bf16 v[144:159], v[184:187], v[72:75], v[144:159]
    s_waitcnt vmcnt(6)
    s_barrier
    ds_read_b64_tr_b16 v[176:177], v225 offset:49152
    ds_read_b64_tr_b16 v[178:179], v225 offset:49664
    s_waitcnt lgkmcnt(2)
    v_mfma_f32_32x32x16_bf16 v[144:159], v[240:243], v[76:79], v[144:159]
    ds_read_b64_tr_b16 v[184:185], v227 offset:49152
    ds_read_b64_tr_b16 v[186:187], v227 offset:49664
    s_waitcnt lgkmcnt(2)
    v_mfma_f32_32x32x16_bf16 v[144:159], v[176:179], v[80:83], v[144:159]
    ds_read_b64_tr_b16 v[240:241], v229 offset:49152
    ds_read_b64_tr_b16 v[242:243], v229 offset:49664
    v_mfma_f32_16x16x32_bf16 v[192:195], v[200:203], v[176:179], v[192:195]
    s_waitcnt lgkmcnt(2)
    v_mfma_f32_32x32x16_bf16 v[144:159], v[184:187], v[84:87], v[144:159]
    ds_read_b64_tr_b16 v[176:177], v231 offset:49152
    ds_read_b64_tr_b16 v[178:179], v231 offset:49664
    s_waitcnt lgkmcnt(2)
    v_mfma_f32_32x32x16_bf16 v[144:159], v[240:243], v[88:91], v[144:159]
    s_waitcnt vmcnt(0) lgkmcnt(0)
    s_barrier
    v_xor_b32 v225, 0x10000, v225
    ds_read_b64_tr_b16 v[184:185], v225 offset:0
    ds_read_b64_tr_b16 v[186:187], v225 offset:512
    buffer_load_dword v3, v239, s[16:19], 0 offen sc1
    v_mul_u32_u24 v6, 2064, v1
    v_mov_b32 v208, 0x3f80
    v_mov_b32 v209, 0
    v_mov_b32 v210, 0
    v_mov_b32 v211, 0
    v_mfma_f32_32x32x16_bf16 v[144:159], v[176:179], v[92:95], v[144:159]
    ds_read_b64_tr_b16 v[240:241], v225 offset:16384
    ds_read_b64_tr_b16 v[242:243], v225 offset:16896
    s_mov_b64 exec, 0x7fffffff
    ds_write_b128 v6, v[208:211] offset:2048
    s_mov_b64 exec, -1
    ds_write_b32 v253, v209
    s_waitcnt lgkmcnt(4)
    v_mfma_f32_32x32x16_bf16 v[144:159], v[184:187], v[96:99], v[144:159]
    ds_read_b64_tr_b16 v[176:177], v225 offset:49152
    ds_read_b64_tr_b16 v[178:179], v225 offset:49664
    v_mov_b32 v48, 0
    v_mov_b32 v49, 0
    v_mov_b32 v50, 0
    v_mov_b32 v51, 0
    v_mov_b32 v52, 0
    v_mov_b32 v53, 0
    v_mov_b32 v54, 0
    v_mov_b32 v55, 0
    v_mov_b32 v56, 0
    v_mov_b32 v57, 0
    v_mov_b32 v58, 0
    v_mov_b32 v59, 0
    v_mov_b32 v60, 0
    v_mov_b32 v61, 0
    v_mov_b32 v62, 0
    v_mov_b32 v63, 0
    v_mfma_f32_16x16x32_bf16 v[192:195], v[200:203], v[184:187], v[192:195]
    s_waitcnt lgkmcnt(4)
    v_mfma_f32_32x32x16_bf16 v[144:159], v[240:243], v[112:115], v[144:159]
    v_xor_b32 v227, 0x10000, v227
    ds_read_b64_tr_b16 v[184:185], v227 offset:0
    ds_read_b64_tr_b16 v[186:187], v227 offset:512
    v_mov_b32 v64, 0
    v_mov_b32 v65, 0
    v_mov_b32 v66, 0
    v_mov_b32 v67, 0
    v_mov_b32 v68, 0
    v_mov_b32 v69, 0
    v_mov_b32 v70, 0
    v_mov_b32 v71, 0
    v_mov_b32 v72, 0
    v_mov_b32 v73, 0
    v_mov_b32 v74, 0
    v_mov_b32 v75, 0
    v_mov_b32 v76, 0
    v_mov_b32 v77, 0
    v_mov_b32 v78, 0
    v_mov_b32 v79, 0
    v_mfma_f32_16x16x32_bf16 v[192:195], v[200:203], v[240:243], v[192:195]
    s_waitcnt lgkmcnt(2)
    v_mfma_f32_32x32x16_bf16 v[144:159], v[176:179], v[128:131], v[144:159]
    v_xor_b32 v229, 0x10000, v229
    ds_read_b64_tr_b16 v[240:241], v229 offset:0
    ds_read_b64_tr_b16 v[242:243], v229 offset:512
    s_waitcnt vmcnt(0)
    v_cmp_ne_u32 vcc, s44, v3
    s_nop 1
    s_cbranch_vccnz RP_13
    s_mov_b32 s85, 16384
    buffer_load_dwordx4 v[8:11], v2, s[16:19], s81 offen sc1
    s_xor_b32 s67, s81, 1024
    buffer_load_dwordx4 v[12:15], v2, s[16:19], s67 offen sc1
    s_branch CK_12
RP_13:
    buffer_load_dword v3, v239, s[16:19], 0 offen sc1
CK_12:
    v_mfma_f32_16x16x32_bf16 v[192:195], v[200:203], v[176:179], v[192:195]
    s_waitcnt lgkmcnt(2)
    v_mfma_f32_32x32x16_bf16 v[144:159], v[184:187], v[100:103], v[144:159]
    v_xor_b32 v231, 0x10000, v231
    ds_read_b64_tr_b16 v[176:177], v231 offset:0
    ds_read_b64_tr_b16 v[178:179], v231 offset:512
    s_cmp_lt_u32 s53, s85
    s_cbranch_scc0 KS_14
    s_mov_b32 m0, s80
    s_xor_b32 s67, s79, s53
    buffer_load_dwordx4 v2, s[16:19], s67 offen sc1 lds
    s_add_u32 s80, s80, 8256
    s_add_u32 s53, s53, 4096
KS_14:
    s_bfe_u32 s64, s78, 0x10006
    s_lshl_b32 s64, s64, 9
    s_bfe_u32 s65, s78, 0x1000d
    s_lshl_b32 s65, s65, 10
    s_add_u32 s64, s64, s65
    s_add_u32 s64, s64, 161792
    v_lshl_add_u32 v7, v4, 4, s64
    s_lshl_b32 s65, s63, 2
    v_add_u32 v212, s65, v7
    ds_write_b32 v212, v192 offset:0
    s_waitcnt lgkmcnt(3)
    v_mfma_f32_32x32x16_bf16 v[144:159], v[240:243], v[104:107], v[144:159]
    ds_read_b64_tr_b16 v[184:185], v227 offset:16384
PAD15:
    s_cbranch_execz SC_BACK
QAD4:
    s_cbranch_execz QAD8
    ds_read_b64_tr_b16 v[186:187], v227 offset:16896
    s_waitcnt lgkmcnt(3)
    v_mfma_f32_32x32x16_bf16 v[144:159], v[176:179], v[108:111], v[144:159]
    s_waitcnt lgkmcnt(2)
    s_barrier
    ds_read_b128 v[192:195], v7 offset:0
    ds_read_b64_tr_b16 v[240:241], v229 offset:16384
    ds_read_b64_tr_b16 v[242:243], v229 offset:16896
    s_cmp_lt_u32 s53, s85
    s_cbranch_scc0 KS_15
    s_mov_b32 m0, s80
    s_xor_b32 s67, s79, s53
    buffer_load_dwordx4 v2, s[16:19], s67 offen sc1 lds
    s_add_u32 s80, s80, 8256
    s_add_u32 s53, s53, 4096
KS_15:
    s_waitcnt lgkmcnt(3)
    v_mfma_f32_32x32x16_bf16 v[144:159], v[184:187], v[116:119], v[144:159]
    ds_read_b64_tr_b16 v[176:177], v231 offset:16384
    ds_read_b64_tr_b16 v[178:179], v231 offset:16896
    s_waitcnt lgkmcnt(4)
    v_add_f32 v192, v192, v193
    v_add_f32 v194, v194, v195
    v_add_f32 v192, v192, v194
    v_cvt_pk_bf16_f32 v193, v192, v192
    v_mov_b32 v195, 0
    v_and_b32 v193, s73, v193
    v_sub_f32 v194, v192, v193
    v_cvt_pk_bf16_f32 v192, v193, v194
    v_mov_b32 v193, v234
    v_mov_b32 v194, 0
    s_cmp_lg_u32 s85, 0
    s_cbranch_scc1 CK_16
    s_waitcnt vmcnt(0)
    v_cmp_ne_u32 vcc, s44, v3
    s_nop 1
    s_cbranch_vccnz RP_17
    s_mov_b32 s85, 16384
    buffer_load_dwordx4 v[8:11], v2, s[16:19], s81 offen sc1
    s_xor_b32 s67, s81, 1024
    buffer_load_dwordx4 v[12:15], v2, s[16:19], s67 offen sc1
    s_branch CK_16
RP_17:
    buffer_load_dword v3, v239, s[16:19], 0 offen sc1
CK_16:
    s_waitcnt lgkmcnt(2)
    v_mfma_f32_32x32x16_bf16 v[144:159], v[240:243], v[120:123], v[144:159]
    ds_read_b64_tr_b16 v[184:185], v227 offset:49152
    ds_read_b64_tr_b16 v[186:187], v227 offset:49664
    s_cmp_lt_u32 s53, s85
    s_cbranch_scc0 KS_18
    s_mov_b32 m0, s80
    s_xor_b32 s67, s79, s53
    buffer_load_dwordx4 v2, s[16:19], s67 offen sc1 lds
    s_add_u32 s80, s80, 8256
    s_add_u32 s53, s53, 4096
KS_18:
    v_mfma_f32_32x32x16_bf16 v[144:159], v[192:195], v[204:207], v[144:159]
    s_waitcnt lgkmcnt(2)
    v_mfma_f32_32x32x16_bf16 v[144:159], v[176:179], v[124:127], v[144:159]
    ds_read_b64_tr_b16 v[240:241], v229 offset:49152
    ds_read_b64_tr_b16 v[242:243], v229 offset:49664
    s_waitcnt lgkmcnt(2)
    v_mfma_f32_32x32x16_bf16 v[144:159], v[184:187], v[132:135], v[144:159]
    ds_read_b64_tr_b16 v[176:177], v231 offset:49152
    ds_read_b64_tr_b16 v[178:179], v231 offset:49664
    s_cmp_lt_u32 s53, s85
    s_cbranch_scc0 KS_19
    s_mov_b32 m0, s80
    s_xor_b32 s67, s79, s53
    buffer_load_dwordx4 v2, s[16:19], s67 offen sc1 lds
    s_add_u32 s80, s80, 8256
    s_add_u32 s53, s53, 4096
KS_19:
    s_waitcnt lgkmcnt(2)
    v_mfma_f32_32x32x16_bf16 v[144:159], v[240:243], v[136:139], v[144:159]
    s_waitcnt lgkmcnt(0)
    v_mfma_f32_32x32x16_bf16 v[144:159], v[176:179], v[140:143], v[144:159]
    s_cmp_lg_u32 s85, 0
    s_cbranch_scc1 C_RDY_1
    s_mov_b32 s95, 4000
    s_branch C_SPIN_1_P
C_SPIN_1:
    buffer_load_dword v3, v239, s[16:19], 0 offen sc1
C_SPIN_1_P:
    s_sub_u32 s95, s95, 1
    s_waitcnt vmcnt(0)
    v_cmp_ne_u32 vcc, s44, v3
    s_cbranch_scc1 C_SPIN_1_X
    s_nop 0
    s_cbranch_vccnz C_SPIN_1
C_SPIN_1_X:
    buffer_load_dwordx4 v[8:11], v2, s[16:19], s81 offen sc1
    s_xor_b32 s67, s81, 1024
    buffer_load_dwordx4 v[12:15], v2, s[16:19], s67 offen sc1
C_RDY_1:
    s_cmp_ge_u32 s53, 16384
    s_cbranch_scc1 C_KV_1
C_KL_1:
    s_mov_b32 m0, s80
    s_xor_b32 s67, s79, s53
    buffer_load_dwordx4 v2, s[16:19], s67 offen sc1 lds
    s_add_u32 s80, s80, 8256
    s_add_u32 s53, s53, 4096
    s_cmp_lt_u32 s53, 16384
    s_cbranch_scc1 C_KL_1
    s_waitcnt vmcnt(0)
C_KV_1:
    s_lshr_b32 s64, s92, 1
    s_mul_i32 s64, s64, 4352
    s_add_u32 s64, s64, 0x1520000
    s_mul_i32 s65, s93, 8704
    s_add_u32 s65, s65, 0x1520000
    s_add_u32 s66, s65, 4352
    v_and_b32 v212, 15, v1
    v_lshl_add_u32 v215, v212, 2, s66
    s_mov_b64 exec, 0xffff
    v_lshl_add_u32 v215, v212, 2, s64
    s_mov_b32 exec_lo, 0xffff0000
    v_lshl_add_u32 v215, v212, 2, s65
    s_mov_b64 exec, -1
    s_waitcnt vmcnt(2) lgkmcnt(0)
    s_barrier
    ds_read_b128 v[176:179], v248
    ds_read_b64_tr_b16 v[180:181], v249
    ds_read_b64_tr_b16 v[182:183], v250
    ds_read_b64_tr_b16 v[184:185], v251
    ds_read_b64_tr_b16 v[186:187], v252
    s_mov_b32 exec_lo, 0x80000000
    ds_write_b128 v6, v[208:211] offset:2048
    s_mov_b32 exec_lo, -1
    v_mul_f32 v214, v233, v233
    v_lshlrev_b32 v7, 2, v4
    v_mul_f32 v144, v144, |v144|
    v_mul_f32 v145, v145, |v145|
    v_mul_f32 v146, v146, |v146|
    v_mul_f32 v147, v147, |v147|
    v_mul_f32 v148, v148, |v148|
    v_mul_f32 v149, v149, |v149|
    v_mul_f32 v150, v150, |v150|
    v_mul_f32 v151, v151, |v151|
    v_cvt_pk_bf16_f32 v144, v144, v145
    v_cvt_pk_bf16_f32 v145, v146, v147
    v_cvt_pk_bf16_f32 v146, v148, v149
    v_cvt_pk_bf16_f32 v147, v150, v151
    v_pk_max_i16 v144, v144, 0
    v_pk_max_i16 v145, v145, 0
    v_pk_max_i16 v146, v146, 0
    v_pk_max_i16 v147, v147, 0
    s_waitcnt lgkmcnt(5)
    v_mfma_f32_32x32x16_bf16 v[16:31], v[176:179], v[8:11], 0
    buffer_store_dwordx4 v[144:147], v2, s[16:19], s75 offen offset:0 sc1
    v_mul_f32 v152, v152, |v152|
    v_mul_f32 v153, v153, |v153|
    v_mul_f32 v154, v154, |v154|
    v_mul_f32 v155, v155, |v155|
    v_mul_f32 v156, v156, |v156|
    v_mul_f32 v157, v157, |v157|
    v_mul_f32 v158, v158, |v158|
    v_mul_f32 v159, v159, |v159|
    v_cvt_pk_bf16_f32 v152, v152, v153
    v_cvt_pk_bf16_f32 v153, v154, v155
    v_cvt_pk_bf16_f32 v154, v156, v157
    v_cvt_pk_bf16_f32 v155, v158, v159
    v_pk_max_i16 v152, v152, 0
    v_pk_max_i16 v153, v153, 0
    v_pk_max_i16 v154, v154, 0
    v_pk_max_i16 v155, v155, 0
    buffer_store_dwordx4 v[152:155], v2, s[16:19], s75 offen offset:1024 sc1
PHC:
QAD5:
    s_cbranch_execz VRET
    v_mov_b32 v239, v215
    s_and_b32 s64, s62, 1
    s_lshl_b32 s64, s64, 8
    s_bfe_u32 s65, s62, 0x10001
    s_lshl_b32 s65, s65, 10
    s_or_b32 s64, s64, s65
    v_xor_b32 v246, s64, v2
    v_xor_b32 v247, 1024, v246
    v_add_u32 v238, s71, v2
    v_lshrrev_b32 v236, 5, v1
    v_and_b32 v237, 31, v1
PAD16:
    s_cbranch_execz SC_BACK
    v_lshlrev_b32 v237, 10, v237
    v_lshl_add_u32 v237, v236, 4, v237
    v_lshlrev_b32 v236, 3, v236
    v_mov_b32 v245, 0xdddddddd
    s_cmp_lt_u32 s62, 4
    s_cbranch_scc1 HS_20
    s_setprio 1
HS_20:
    v_mfma_f32_32x32x16_bf16 v[32:47], v[176:179], v[12:15], 0
    s_add_u32 m0, s80, 0
    s_xor_b32 s67, s79, 16384
    buffer_load_dwordx4 v2, s[16:19], s67 offen sc1 lds
    ds_read_b128 v[176:179], v248 offset:4128
    v_exp_f32 v16, v16
    v_exp_f32 v17, v17
    v_exp_f32 v18, v18
    v_exp_f32 v19, v19
    v_exp_f32 v20, v20
    v_exp_f32 v21, v21
    v_exp_f32 v22, v22
    v_exp_f32 v23, v23
    v_exp_f32 v188, v24
    v_exp_f32 v189, v25
    v_exp_f32 v190, v26
    s_waitcnt lgkmcnt(4)
    v_smfmac_f32_32x32x32_bf16 v[48:63], v[180:183], v[16:23], v245
    v_exp_f32 v191, v27
    v_exp_f32 v192, v28
    v_exp_f32 v193, v29
    v_exp_f32 v194, v30
    v_exp_f32 v195, v31
    s_waitcnt lgkmcnt(0)
    v_mfma_f32_32x32x16_bf16 v[16:31], v[176:179], v[8:11], 0
    s_add_u32 m0, s80, 8256
    s_xor_b32 s67, s79, 20480
    buffer_load_dwordx4 v2, s[16:19], s67 offen sc1 lds
    v_exp_f32 v32, v32
    v_exp_f32 v33, v33
    v_exp_f32 v34, v34
    v_exp_f32 v35, v35
    v_exp_f32 v36, v36
    v_smfmac_f32_32x32x32_bf16 v[48:63], v[184:187], v[188:195], v245
    v_exp_f32 v37, v37
    v_exp_f32 v38, v38
    v_exp_f32 v39, v39
    v_exp_f32 v188, v40
    v_exp_f32 v189, v41
    v_exp_f32 v190, v42
    v_smfmac_f32_32x32x32_bf16 v[64:79], v[180:183], v[32:39], v245
    ds_read_b64_tr_b16 v[180:181], v249 offset:4128
    ds_read_b64_tr_b16 v[182:183], v250 offset:4128
    v_exp_f32 v191, v43
    v_exp_f32 v192, v44
    v_exp_f32 v193, v45
    v_exp_f32 v194, v46
    v_exp_f32 v195, v47
    s_setprio 0
    v_mfma_f32_32x32x16_bf16 v[32:47], v[176:179], v[12:15], 0
    s_add_u32 m0, s80, 16512
    s_xor_b32 s67, s79, 24576
    buffer_load_dwordx4 v2, s[16:19], s67 offen sc1 lds
    ds_read_b128 v[176:179], v248 offset:8256
    v_exp_f32 v16, v16
    v_exp_f32 v17, v17
    v_exp_f32 v18, v18
    v_exp_f32 v19, v19
    v_exp_f32 v20, v20
    v_smfmac_f32_32x32x32_bf16 v[64:79], v[184:187], v[188:195], v245
    ds_read_b64_tr_b16 v[184:185], v251 offset:4128
    ds_read_b64_tr_b16 v[186:187], v252 offset:4128
    v_exp_f32 v21, v21
    v_exp_f32 v22, v22
    v_exp_f32 v23, v23
    v_exp_f32 v188, v24
    v_exp_f32 v189, v25
    v_exp_f32 v190, v26
    s_waitcnt lgkmcnt(3)
    v_smfmac_f32_32x32x32_bf16 v[48:63], v[180:183], v[16:23], v245
    v_exp_f32 v191, v27
    v_exp_f32 v192, v28
    v_exp_f32 v193, v29
    v_exp_f32 v194, v30
    v_exp_f32 v195, v31
    s_waitcnt lgkmcnt(2)
    v_mfma_f32_32x32x16_bf16 v[16:31], v[176:179], v[8:11], 0
    s_add_u32 m0, s80, 24768
    s_xor_b32 s67, s79, 28672
    buffer_load_dwordx4 v2, s[16:19], s67 offen sc1 lds
    v_exp_f32 v32, v32
    v_exp_f32 v33, v33
    v_exp_f32 v34, v34
    v_exp_f32 v35, v35
    v_exp_f32 v36, v36
    s_waitcnt lgkmcnt(0)
    v_smfmac_f32_32x32x32_bf16 v[48:63], v[184:187], v[188:195], v245
    v_exp_f32 v37, v37
    v_exp_f32 v38, v38
    v_exp_f32 v39, v39
    v_exp_f32 v188, v40
    v_exp_f32 v189, v41
    v_exp_f32 v190, v42
    v_smfmac_f32_32x32x32_bf16 v[64:79], v[180:183], v[32:39], v245
    ds_read_b64_tr_b16 v[180:181], v249 offset:8256
    ds_read_b64_tr_b16 v[182:183], v250 offset:8256
    v_exp_f32 v191, v43
    v_exp_f32 v192, v44
    v_exp_f32 v193, v45
    v_exp_f32 v194, v46
    v_exp_f32 v195, v47
    v_mfma_f32_32x32x16_bf16 v[32:47], v[176:179], v[12:15], 0
    s_add_u32 m0, s80, 33024
    s_xor_b32 s67, s79, 32768
    buffer_load_dwordx4 v2, s[16:19], s67 offen sc1 lds
    ds_read_b128 v[176:179], v248 offset:12384
    v_exp_f32 v16, v16
    v_exp_f32 v17, v17
    v_exp_f32 v18, v18
    v_exp_f32 v19, v19
    v_exp_f32 v20, v20
    v_smfmac_f32_32x32x32_bf16 v[64:79], v[184:187], v[188:195], v245
    ds_read_b64_tr_b16 v[184:185], v251 offset:8256
    ds_read_b64_tr_b16 v[186:187], v252 offset:8256
    v_exp_f32 v21, v21
    v_exp_f32 v22, v22
    v_exp_f32 v23, v23
    v_exp_f32 v188, v24
    v_exp_f32 v189, v25
    v_exp_f32 v190, v26
    s_waitcnt lgkmcnt(3)
    v_smfmac_f32_32x32x32_bf16 v[48:63], v[180:183], v[16:23], v245
    v_exp_f32 v191, v27
    v_exp_f32 v192, v28
    v_exp_f32 v193, v29
    v_exp_f32 v194, v30
    v_exp_f32 v195, v31
    s_waitcnt lgkmcnt(2)
    v_mfma_f32_32x32x16_bf16 v[16:31], v[176:179], v[8:11], 0
    s_add_u32 m0, s80, 41280
    s_xor_b32 s67, s79, 36864
    buffer_load_dwordx4 v2, s[16:19], s67 offen sc1 lds
    v_exp_f32 v32, v32
    v_exp_f32 v33, v33
    v_exp_f32 v34, v34
    v_exp_f32 v35, v35
    v_exp_f32 v36, v36
    s_waitcnt lgkmcnt(0)
    v_smfmac_f32_32x32x32_bf16 v[48:63], v[184:187], v[188:195], v245
    v_exp_f32 v37, v37
    v_exp_f32 v38, v38
    v_exp_f32 v39, v39
    v_exp_f32 v188, v40
    v_exp_f32 v189, v41
    v_exp_f32 v190, v42
    v_smfmac_f32_32x32x32_bf16 v[64:79], v[180:183], v[32:39], v245
    ds_read_b64_tr_b16 v[180:181], v249 offset:12384
    ds_read_b64_tr_b16 v[182:183], v250 offset:12384
    v_exp_f32 v191, v43
    v_exp_f32 v192, v44
    v_exp_f32 v193, v45
    v_exp_f32 v194, v46
    v_exp_f32 v195, v47
    s_waitcnt vmcnt(2)
    s_barrier
    s_cmp_lg_u32 s62, 0
    s_cbranch_scc1 PUB_21
    v_mov_b32 v3, s44
    s_mov_b64 exec, 1
    buffer_store_dword v3, off, s[16:19], s46 sc1
    s_mov_b64 exec, -1
PUB_21:
    v_mfma_f32_32x32x16_bf16 v[32:47], v[176:179], v[12:15], 0
    s_add_u32 m0, s80, 49536
    s_xor_b32 s67, s79, 40960
    buffer_load_dwordx4 v2, s[16:19], s67 offen sc1 lds
    ds_read_b128 v[176:179], v248 offset:16512
    v_exp_f32 v16, v16
    v_exp_f32 v17, v17
    v_exp_f32 v18, v18
    v_exp_f32 v19, v19
    v_exp_f32 v20, v20
    v_smfmac_f32_32x32x32_bf16 v[64:79], v[184:187], v[188:195], v245
    ds_read_b64_tr_b16 v[184:185], v251 offset:12384
    ds_read_b64_tr_b16 v[186:187], v252 offset:12384
    v_exp_f32 v21, v21
    v_exp_f32 v22, v22
    v_exp_f32 v23, v23
    v_exp_f32 v188, v24
    v_exp_f32 v189, v25
    v_exp_f32 v190, v26
    s_waitcnt lgkmcnt(3)
    v_smfmac_f32_32x32x32_bf16 v[48:63], v[180:183], v[16:23], v245
    v_exp_f32 v191, v27
    v_exp_f32 v192, v28
    v_exp_f32 v193, v29
    v_exp_f32 v194, v30
    v_exp_f32 v195, v31
    s_waitcnt lgkmcnt(2)
    v_mfma_f32_32x32x16_bf16 v[16:31], v[176:179], v[8:11], 0
    s_add_u32 m0, s80, 57792
    s_xor_b32 s67, s79, 45056
    buffer_load_dwordx4 v2, s[16:19], s67 offen sc1 lds
    v_exp_f32 v32, v32
    v_exp_f32 v33, v33
    v_exp_f32 v34, v34
    v_exp_f32 v35, v35
    v_exp_f32 v36, v36
    s_waitcnt lgkmcnt(0)
    v_smfmac_f32_32x32x32_bf16 v[48:63], v[184:187], v[188:195], v245
    v_exp_f32 v37, v37
PAD17:
    s_cbranch_execz SC_BACK
    v_exp_f32 v38, v38
    v_exp_f32 v39, v39
    v_exp_f32 v188, v40
    v_exp_f32 v189, v41
    v_exp_f32 v190, v42
    v_smfmac_f32_32x32x32_bf16 v[64:79], v[180:183], v[32:39], v245
    ds_read_b64_tr_b16 v[180:181], v249 offset:16512
    ds_read_b64_tr_b16 v[182:183], v250 offset:16512
    v_exp_f32 v191, v43
    v_exp_f32 v192, v44
    v_exp_f32 v193, v45
    v_exp_f32 v194, v46
    v_exp_f32 v195, v47
    v_mfma_f32_32x32x16_bf16 v[32:47], v[176:179], v[12:15], 0
    s_add_u32 m0, s80, 66048
    s_xor_b32 s67, s79, 49152
    buffer_load_dwordx4 v2, s[16:19], s67 offen sc1 lds
    ds_read_b128 v[176:179], v248 offset:20640
    v_mov_b32 v255, 8
    ds_write_b32 v253, v255
    ds_read_b32 v255, v254
    v_exp_f32 v16, v16
    v_exp_f32 v17, v17
    v_exp_f32 v18, v18
    v_exp_f32 v19, v19
    v_exp_f32 v20, v20
    v_smfmac_f32_32x32x32_bf16 v[64:79], v[184:187], v[188:195], v245
    ds_read_b64_tr_b16 v[184:185], v251 offset:16512
    ds_read_b64_tr_b16 v[186:187], v252 offset:16512
    v_exp_f32 v21, v21
    v_exp_f32 v22, v22
    v_exp_f32 v23, v23
    v_exp_f32 v188, v24
    v_exp_f32 v189, v25
    v_exp_f32 v190, v26
    s_waitcnt lgkmcnt(5)
    v_smfmac_f32_32x32x32_bf16 v[48:63], v[180:183], v[16:23], v245
    v_exp_f32 v191, v27
    v_exp_f32 v192, v28
    v_exp_f32 v193, v29
    v_exp_f32 v194, v30
    v_exp_f32 v195, v31
    s_waitcnt lgkmcnt(4)
    v_mfma_f32_32x32x16_bf16 v[16:31], v[176:179], v[8:11], 0
    s_add_u32 m0, s80, 74304
    s_xor_b32 s67, s79, 53248
    buffer_load_dwordx4 v2, s[16:19], s67 offen sc1 lds
    v_exp_f32 v32, v32
    v_exp_f32 v33, v33
    v_exp_f32 v34, v34
    v_exp_f32 v35, v35
    s_waitcnt lgkmcnt(2)
    v_readfirstlane_b32 s65, v255
    v_exp_f32 v36, v36
    s_waitcnt lgkmcnt(0)
    v_smfmac_f32_32x32x32_bf16 v[48:63], v[184:187], v[188:195], v245
    v_exp_f32 v37, v37
    v_exp_f32 v38, v38
    v_exp_f32 v39, v39
    s_cmp_ge_u32 s65, 8
    s_cbranch_scc0 PL_22
    s_setprio 1
    s_branch PD_23
PL_22:
    s_setprio 0
PD_23:
    v_exp_f32 v188, v40
    v_exp_f32 v189, v41
    v_exp_f32 v190, v42
    v_smfmac_f32_32x32x32_bf16 v[64:79], v[180:183], v[32:39], v245
    ds_read_b64_tr_b16 v[180:181], v249 offset:20640
    ds_read_b64_tr_b16 v[182:183], v250 offset:20640
    v_exp_f32 v191, v43
    v_exp_f32 v192, v44
    v_exp_f32 v193, v45
    v_exp_f32 v194, v46
    v_exp_f32 v195, v47
    v_mfma_f32_32x32x16_bf16 v[32:47], v[176:179], v[12:15], 0
    s_add_u32 m0, s80, 82560
    s_xor_b32 s67, s79, 57344
    buffer_load_dwordx4 v2, s[16:19], s67 offen sc1 lds
    ds_read_b128 v[176:179], v248 offset:24768
    v_exp_f32 v16, v16
    v_exp_f32 v17, v17
    v_exp_f32 v18, v18
    v_exp_f32 v19, v19
    v_exp_f32 v20, v20
    v_smfmac_f32_32x32x32_bf16 v[64:79], v[184:187], v[188:195], v245
    ds_read_b64_tr_b16 v[184:185], v251 offset:20640
    ds_read_b64_tr_b16 v[186:187], v252 offset:20640
    v_exp_f32 v21, v21
    v_exp_f32 v22, v22
    v_exp_f32 v23, v23
    v_exp_f32 v188, v24
    v_exp_f32 v189, v25
    v_exp_f32 v190, v26
    s_waitcnt lgkmcnt(3)
    v_smfmac_f32_32x32x32_bf16 v[48:63], v[180:183], v[16:23], v245
    v_exp_f32 v191, v27
    v_exp_f32 v192, v28
    v_exp_f32 v193, v29
    v_exp_f32 v194, v30
    v_exp_f32 v195, v31
    s_waitcnt lgkmcnt(2)
    v_mfma_f32_32x32x16_bf16 v[16:31], v[176:179], v[8:11], 0
    s_add_u32 m0, s80, 90816
    s_xor_b32 s67, s79, 61440
    buffer_load_dwordx4 v2, s[16:19], s67 offen sc1 lds
    v_exp_f32 v32, v32
    v_exp_f32 v33, v33
    v_exp_f32 v34, v34
    v_exp_f32 v35, v35
    v_exp_f32 v36, v36
    s_waitcnt lgkmcnt(0)
    v_smfmac_f32_32x32x32_bf16 v[48:63], v[184:187], v[188:195], v245
    v_exp_f32 v37, v37
    v_exp_f32 v38, v38
    v_exp_f32 v39, v39
    v_exp_f32 v188, v40
    v_exp_f32 v189, v41
    v_exp_f32 v190, v42
    v_smfmac_f32_32x32x32_bf16 v[64:79], v[180:183], v[32:39], v245
    ds_read_b64_tr_b16 v[180:181], v249 offset:24768
    ds_read_b64_tr_b16 v[182:183], v250 offset:24768
    v_exp_f32 v191, v43
    v_exp_f32 v192, v44
    v_exp_f32 v193, v45
    v_exp_f32 v194, v46
    v_exp_f32 v195, v47
    v_mfma_f32_32x32x16_bf16 v[32:47], v[176:179], v[12:15], 0
    ds_read_b128 v[176:179], v248 offset:28896
    v_exp_f32 v16, v16
    v_exp_f32 v17, v17
    v_exp_f32 v18, v18
    v_exp_f32 v19, v19
    v_exp_f32 v20, v20
    v_smfmac_f32_32x32x32_bf16 v[64:79], v[184:187], v[188:195], v245
    ds_read_b64_tr_b16 v[184:185], v251 offset:24768
    ds_read_b64_tr_b16 v[186:187], v252 offset:24768
    v_exp_f32 v21, v21
    v_exp_f32 v22, v22
    v_exp_f32 v23, v23
    v_exp_f32 v188, v24
    v_exp_f32 v189, v25
    v_exp_f32 v190, v26
    s_waitcnt lgkmcnt(3)
    v_smfmac_f32_32x32x32_bf16 v[48:63], v[180:183], v[16:23], v245
    v_exp_f32 v191, v27
    v_exp_f32 v192, v28
    v_exp_f32 v193, v29
    v_exp_f32 v194, v30
    v_exp_f32 v195, v31
    s_waitcnt lgkmcnt(2)
    v_mfma_f32_32x32x16_bf16 v[16:31], v[176:179], v[8:11], 0
    v_exp_f32 v32, v32
    v_exp_f32 v33, v33
    v_exp_f32 v34, v34
    v_exp_f32 v35, v35
    v_exp_f32 v36, v36
    s_waitcnt lgkmcnt(0)
    v_smfmac_f32_32x32x32_bf16 v[48:63], v[184:187], v[188:195], v245
    v_exp_f32 v37, v37
    v_exp_f32 v38, v38
    v_exp_f32 v39, v39
    v_exp_f32 v188, v40
    v_exp_f32 v189, v41
    v_exp_f32 v190, v42
    v_smfmac_f32_32x32x32_bf16 v[64:79], v[180:183], v[32:39], v245
    ds_read_b64_tr_b16 v[180:181], v249 offset:28896
    ds_read_b64_tr_b16 v[182:183], v250 offset:28896
    v_exp_f32 v191, v43
    v_exp_f32 v192, v44
    v_exp_f32 v193, v45
    v_exp_f32 v194, v46
    v_exp_f32 v195, v47
    buffer_load_dword v3, v239, s[16:19], 0 offen sc1
    v_mfma_f32_32x32x16_bf16 v[32:47], v[176:179], v[12:15], 0
    ds_read_b128 v[176:179], v248 offset:33024
    v_exp_f32 v16, v16
    v_exp_f32 v17, v17
    v_exp_f32 v18, v18
    v_exp_f32 v19, v19
    v_exp_f32 v20, v20
    v_smfmac_f32_32x32x32_bf16 v[64:79], v[184:187], v[188:195], v245
    ds_read_b64_tr_b16 v[184:185], v251 offset:28896
    ds_read_b64_tr_b16 v[186:187], v252 offset:28896
    v_exp_f32 v21, v21
    v_exp_f32 v22, v22
    v_exp_f32 v23, v23
    v_exp_f32 v188, v24
    v_exp_f32 v189, v25
    v_exp_f32 v190, v26
    s_waitcnt lgkmcnt(3)
    v_smfmac_f32_32x32x32_bf16 v[48:63], v[180:183], v[16:23], v245
    v_exp_f32 v191, v27
    v_exp_f32 v192, v28
    v_exp_f32 v193, v29
    v_exp_f32 v194, v30
    v_exp_f32 v195, v31
    s_waitcnt lgkmcnt(2)
    v_mfma_f32_32x32x16_bf16 v[16:31], v[176:179], v[8:11], 0
    v_exp_f32 v32, v32
    v_exp_f32 v33, v33
    v_exp_f32 v34, v34
    v_exp_f32 v35, v35
    v_exp_f32 v36, v36
    s_waitcnt lgkmcnt(0)
    v_smfmac_f32_32x32x32_bf16 v[48:63], v[184:187], v[188:195], v245
    v_exp_f32 v37, v37
    v_exp_f32 v38, v38
    v_exp_f32 v39, v39
    v_exp_f32 v188, v40
    v_exp_f32 v189, v41
    v_exp_f32 v190, v42
PAD18:
    s_cbranch_execz SC_BACK
    v_smfmac_f32_32x32x32_bf16 v[64:79], v[180:183], v[32:39], v245
    ds_read_b64_tr_b16 v[180:181], v249 offset:33024
    ds_read_b64_tr_b16 v[182:183], v250 offset:33024
    v_exp_f32 v191, v43
    v_exp_f32 v192, v44
    v_exp_f32 v193, v45
    v_exp_f32 v194, v46
    v_exp_f32 v195, v47
    s_waitcnt vmcnt(1)
    s_barrier
    v_mfma_f32_32x32x16_bf16 v[32:47], v[176:179], v[12:15], 0
    ds_read_b128 v[176:179], v248 offset:37152
    v_mov_b32 v255, 16
    ds_write_b32 v253, v255
    ds_read_b32 v255, v254
    v_exp_f32 v16, v16
    v_exp_f32 v17, v17
    v_exp_f32 v18, v18
    v_exp_f32 v19, v19
    v_exp_f32 v20, v20
    v_smfmac_f32_32x32x32_bf16 v[64:79], v[184:187], v[188:195], v245
    ds_read_b64_tr_b16 v[184:185], v251 offset:33024
    ds_read_b64_tr_b16 v[186:187], v252 offset:33024
    v_exp_f32 v21, v21
    v_exp_f32 v22, v22
    v_exp_f32 v23, v23
    v_exp_f32 v188, v24
    v_exp_f32 v189, v25
    v_exp_f32 v190, v26
    s_waitcnt lgkmcnt(5)
    v_smfmac_f32_32x32x32_bf16 v[48:63], v[180:183], v[16:23], v245
    v_exp_f32 v191, v27
    v_exp_f32 v192, v28
    v_exp_f32 v193, v29
    v_exp_f32 v194, v30
    v_exp_f32 v195, v31
    s_waitcnt lgkmcnt(4)
    v_mfma_f32_32x32x16_bf16 v[16:31], v[176:179], v[8:11], 0
    v_exp_f32 v32, v32
    v_exp_f32 v33, v33
    v_exp_f32 v34, v34
    v_exp_f32 v35, v35
    s_waitcnt lgkmcnt(2)
    v_readfirstlane_b32 s65, v255
    v_exp_f32 v36, v36
    s_waitcnt lgkmcnt(0)
    v_smfmac_f32_32x32x32_bf16 v[48:63], v[184:187], v[188:195], v245
    v_exp_f32 v37, v37
    v_exp_f32 v38, v38
    v_exp_f32 v39, v39
    s_cmp_ge_u32 s65, 16
    s_cbranch_scc0 PL_24
    s_setprio 1
    s_branch PD_25
PL_24:
    s_setprio 0
PD_25:
    v_exp_f32 v188, v40
    v_exp_f32 v189, v41
    v_exp_f32 v190, v42
    v_smfmac_f32_32x32x32_bf16 v[64:79], v[180:183], v[32:39], v245
    ds_read_b64_tr_b16 v[180:181], v249 offset:37152
    ds_read_b64_tr_b16 v[182:183], v250 offset:37152
    v_exp_f32 v191, v43
    v_exp_f32 v192, v44
    v_exp_f32 v193, v45
    s_mov_b32 s95, 4000
    s_waitcnt vmcnt(0)
    v_cmp_ne_u32 vcc, s44, v3
    s_nop 1
    s_cbranch_vccz C_F2
    s_mov_b32 s95, 4000
C_SPIN2:
    buffer_load_dword v3, v239, s[16:19], 0 offen sc1
C_SPIN2_P:
    s_sub_u32 s95, s95, 1
    s_waitcnt vmcnt(0)
    v_cmp_ne_u32 vcc, s44, v3
    s_cbranch_scc1 C_SPIN2_X
    s_nop 0
    s_cbranch_vccnz C_SPIN2
C_SPIN2_X:
C_F2:
    buffer_load_dwordx4 v[144:147], v2, s[16:19], s82 offen offset:0 sc1
    v_exp_f32 v194, v46
    v_exp_f32 v195, v47
    v_mfma_f32_32x32x16_bf16 v[32:47], v[176:179], v[12:15], 0
    ds_read_b128 v[176:179], v248 offset:41280
    v_exp_f32 v16, v16
    v_exp_f32 v17, v17
    v_exp_f32 v18, v18
    v_exp_f32 v19, v19
    v_exp_f32 v20, v20
    v_smfmac_f32_32x32x32_bf16 v[64:79], v[184:187], v[188:195], v245
    ds_read_b64_tr_b16 v[184:185], v251 offset:37152
    ds_read_b64_tr_b16 v[186:187], v252 offset:37152
    v_exp_f32 v21, v21
    v_exp_f32 v22, v22
    v_exp_f32 v23, v23
    buffer_load_dwordx4 v[152:155], v246, s[16:19], s83 offen offset:0 sc1
    v_exp_f32 v188, v24
    v_exp_f32 v189, v25
    v_exp_f32 v190, v26
    s_waitcnt lgkmcnt(3)
    v_smfmac_f32_32x32x32_bf16 v[48:63], v[180:183], v[16:23], v245
    v_exp_f32 v191, v27
    v_exp_f32 v192, v28
    v_exp_f32 v193, v29
    buffer_load_dwordx4 v[156:159], v247, s[16:19], s83 offen offset:0 sc1
    v_exp_f32 v194, v30
    v_exp_f32 v195, v31
    s_waitcnt lgkmcnt(2)
    v_mfma_f32_32x32x16_bf16 v[16:31], v[176:179], v[8:11], 0
    v_exp_f32 v32, v32
    v_exp_f32 v33, v33
    v_exp_f32 v34, v34
    v_exp_f32 v35, v35
    v_exp_f32 v36, v36
    s_waitcnt lgkmcnt(0)
    v_smfmac_f32_32x32x32_bf16 v[48:63], v[184:187], v[188:195], v245
    v_exp_f32 v37, v37
    v_exp_f32 v38, v38
    v_exp_f32 v39, v39
    buffer_load_dwordx4 v[148:151], v2, s[16:19], s59 offen offset:0 sc1
    v_exp_f32 v188, v40
    v_exp_f32 v189, v41
    v_exp_f32 v190, v42
    v_smfmac_f32_32x32x32_bf16 v[64:79], v[180:183], v[32:39], v245
    ds_read_b64_tr_b16 v[180:181], v249 offset:41280
    ds_read_b64_tr_b16 v[182:183], v250 offset:41280
    v_exp_f32 v191, v43
    v_exp_f32 v192, v44
    v_exp_f32 v193, v45
    buffer_load_dwordx4 v[160:163], v2, s[16:19], s82 offen offset:1024 sc1
    v_exp_f32 v194, v46
    v_exp_f32 v195, v47
    v_mfma_f32_32x32x16_bf16 v[32:47], v[176:179], v[12:15], 0
    ds_read_b128 v[176:179], v248 offset:45408
    s_lshl_b32 s48, s63, 17
    s_lshl_b32 s65, s93, 11
    s_add_u32 s48, s48, s65
    s_add_u32 s48, s48, 0xec0000
    s_lshl_b32 s49, s93, 7
    s_lshl_b32 s65, s63, 5
    s_add_u32 s49, s49, s65
    v_exp_f32 v16, v16
    v_exp_f32 v17, v17
    v_exp_f32 v18, v18
    v_exp_f32 v19, v19
    v_exp_f32 v20, v20
    v_smfmac_f32_32x32x32_bf16 v[64:79], v[184:187], v[188:195], v245
    ds_read_b64_tr_b16 v[184:185], v251 offset:41280
    ds_read_b64_tr_b16 v[186:187], v252 offset:41280
    v_exp_f32 v21, v21
    v_exp_f32 v22, v22
    v_exp_f32 v23, v23
    s_add_u32 s64, s83, 16384
    buffer_load_dwordx4 v[168:171], v246, s[16:19], s64 offen offset:0 sc1
    v_exp_f32 v188, v24
    v_exp_f32 v189, v25
    v_exp_f32 v190, v26
    s_waitcnt lgkmcnt(3)
    v_smfmac_f32_32x32x32_bf16 v[48:63], v[180:183], v[16:23], v245
    v_exp_f32 v191, v27
    v_exp_f32 v192, v28
    v_exp_f32 v193, v29
    s_add_u32 s64, s83, 16384
    buffer_load_dwordx4 v[172:175], v247, s[16:19], s64 offen offset:0 sc1
PAD19:
    s_cbranch_execz SC_BACK
QAD6:
    s_cbranch_execz VRET
    v_exp_f32 v194, v30
    v_exp_f32 v195, v31
    s_waitcnt lgkmcnt(2)
    v_mfma_f32_32x32x16_bf16 v[16:31], v[176:179], v[8:11], 0
    s_lshl_b32 s65, s92, 1
    s_lshr_b32 s66, s62, 2
    s_add_u32 s65, s65, s66
    s_lshl_b32 s50, s65, 7
    s_add_u32 s50, s50, 0x1400000
    s_lshl_b32 s65, s65, 15
    s_add_u32 s68, s65, s49
    s_lshl_b32 s66, s63, 13
    s_add_u32 s51, s65, s66
    s_add_u32 s51, s51, 0x1000000
    s_add_u32 s52, s51, 4096
    v_exp_f32 v32, v32
    v_exp_f32 v33, v33
    v_exp_f32 v34, v34
    v_exp_f32 v35, v35
    v_exp_f32 v36, v36
    s_waitcnt lgkmcnt(0)
    v_smfmac_f32_32x32x32_bf16 v[48:63], v[184:187], v[188:195], v245
    v_exp_f32 v37, v37
    v_exp_f32 v38, v38
    v_exp_f32 v39, v39
    buffer_load_dwordx4 v[164:167], v2, s[16:19], s59 offen offset:1024 sc1
    v_exp_f32 v188, v40
    v_exp_f32 v189, v41
    v_exp_f32 v190, v42
    v_smfmac_f32_32x32x32_bf16 v[64:79], v[180:183], v[32:39], v245
    ds_read_b64_tr_b16 v[180:181], v249 offset:45408
    ds_read_b64_tr_b16 v[182:183], v250 offset:45408
    v_exp_f32 v191, v43
    v_exp_f32 v192, v44
    v_exp_f32 v193, v45
    buffer_load_dwordx4 v[196:199], v2, s[16:19], s82 offen offset:2048 sc1
    v_exp_f32 v194, v46
    v_exp_f32 v195, v47
    v_mfma_f32_32x32x16_bf16 v[32:47], v[176:179], v[12:15], 0
    ds_read_b128 v[176:179], v248 offset:49536
    s_mul_i32 s65, s62, 3072
    s_add_u32 s65, s65, 139264
    v_add_u32 v5, s65, v2
    v_exp_f32 v16, v16
    v_exp_f32 v17, v17
    v_exp_f32 v18, v18
    v_smfmac_f32_32x32x32_bf16 v[64:79], v[184:187], v[188:195], v245
    ds_read_b64_tr_b16 v[184:185], v251 offset:45408
    ds_read_b64_tr_b16 v[186:187], v252 offset:45408
    v_exp_f32 v19, v19
    v_exp_f32 v20, v20
    v_exp_f32 v21, v21
    s_waitcnt vmcnt(7)
    v_mfma_f32_32x32x16_bf16 v[80:95], v[152:155], v[144:147], 0
    s_add_u32 s64, s83, 32768
    buffer_load_dwordx4 v[204:207], v246, s[16:19], s64 offen offset:0 sc1
    v_exp_f32 v22, v22
    v_exp_f32 v23, v23
    v_exp_f32 v188, v24
    v_exp_f32 v189, v25
    s_waitcnt lgkmcnt(3)
    v_smfmac_f32_32x32x32_bf16 v[48:63], v[180:183], v[16:23], v245
    v_exp_f32 v190, v26
    v_exp_f32 v191, v27
    v_exp_f32 v192, v28
    s_waitcnt vmcnt(7)
    v_mfma_f32_32x32x16_bf16 v[96:111], v[156:159], v[144:147], 0
    s_add_u32 s64, s83, 32768
    buffer_load_dwordx4 v[208:211], v247, s[16:19], s64 offen offset:0 sc1
    v_exp_f32 v193, v29
    v_exp_f32 v194, v30
    v_exp_f32 v195, v31
    s_waitcnt lgkmcnt(2)
    v_mfma_f32_32x32x16_bf16 v[16:31], v[176:179], v[8:11], 0
    s_xor_b32 s65, s62, 4
    s_mul_i32 s65, s65, 3072
    s_add_u32 s65, s65, 139264
    v_add_u32 v6, s65, v2
    v_exp_f32 v32, v32
    v_exp_f32 v33, v33
    v_exp_f32 v34, v34
    s_waitcnt lgkmcnt(0)
    v_smfmac_f32_32x32x32_bf16 v[48:63], v[184:187], v[188:195], v245
    v_exp_f32 v35, v35
    v_exp_f32 v36, v36
    v_exp_f32 v37, v37
    s_waitcnt vmcnt(7)
    v_mfma_f32_32x32x16_bf16 v[128:143], v[156:159], v[148:151], 0
    buffer_load_dwordx4 v[200:203], v2, s[16:19], s59 offen offset:2048 sc1
    v_exp_f32 v38, v38
    v_exp_f32 v39, v39
    v_exp_f32 v188, v40
    v_exp_f32 v189, v41
    v_smfmac_f32_32x32x32_bf16 v[64:79], v[180:183], v[32:39], v245
    ds_read_b64_tr_b16 v[180:181], v249 offset:49536
    ds_read_b64_tr_b16 v[182:183], v250 offset:49536
    v_exp_f32 v190, v42
    v_exp_f32 v191, v43
    v_exp_f32 v192, v44
    v_mfma_f32_32x32x16_bf16 v[112:127], v[152:155], v[148:151], 0
    buffer_load_dwordx4 v[144:147], v2, s[16:19], s82 offen offset:3072 sc1
    v_exp_f32 v193, v45
    v_exp_f32 v194, v46
    v_exp_f32 v195, v47
    v_mfma_f32_32x32x16_bf16 v[32:47], v[176:179], v[12:15], 0
    ds_read_b128 v[176:179], v248 offset:53664
    v_mov_b32 v255, 24
    ds_write_b32 v253, v255
    ds_read_b32 v255, v254
    v_exp_f32 v16, v16
    v_exp_f32 v17, v17
    v_exp_f32 v18, v18
    v_smfmac_f32_32x32x32_bf16 v[64:79], v[184:187], v[188:195], v245
    ds_read_b64_tr_b16 v[184:185], v251 offset:49536
    ds_read_b64_tr_b16 v[186:187], v252 offset:49536
    v_exp_f32 v19, v19
    v_exp_f32 v20, v20
    v_exp_f32 v21, v21
    s_waitcnt vmcnt(7)
    v_mfma_f32_32x32x16_bf16 v[80:95], v[168:171], v[160:163], v[80:95]
    s_add_u32 s64, s83, 49152
    buffer_load_dwordx4 v[156:159], v247, s[16:19], s64 offen offset:0 sc1
    v_exp_f32 v22, v22
    v_exp_f32 v23, v23
    v_exp_f32 v188, v24
    v_exp_f32 v189, v25
    s_waitcnt lgkmcnt(5)
    v_smfmac_f32_32x32x32_bf16 v[48:63], v[180:183], v[16:23], v245
    v_exp_f32 v190, v26
    v_exp_f32 v191, v27
    v_exp_f32 v192, v28
    s_waitcnt vmcnt(7)
    v_mfma_f32_32x32x16_bf16 v[96:111], v[172:175], v[160:163], v[96:111]
    buffer_load_dwordx4 v[148:151], v2, s[16:19], s59 offen offset:3072 sc1
    v_exp_f32 v193, v29
    v_exp_f32 v194, v30
    v_exp_f32 v195, v31
    s_waitcnt lgkmcnt(4)
    v_mfma_f32_32x32x16_bf16 v[16:31], v[176:179], v[8:11], 0
    v_exp_f32 v32, v32
    v_exp_f32 v33, v33
    v_exp_f32 v34, v34
    v_exp_f32 v35, v35
    s_waitcnt lgkmcnt(0)
    v_smfmac_f32_32x32x32_bf16 v[48:63], v[184:187], v[188:195], v245
    v_readfirstlane_b32 s65, v255
    v_exp_f32 v36, v36
    v_exp_f32 v37, v37
    v_exp_f32 v38, v38
    v_exp_f32 v39, v39
    s_cmp_ge_u32 s65, 24
    s_cbranch_scc0 PL_26
    s_setprio 1
    s_branch PD_27
PL_26:
    s_setprio 0
PD_27:
    s_waitcnt vmcnt(7)
    v_mfma_f32_32x32x16_bf16 v[128:143], v[172:175], v[164:167], v[128:143]
    s_add_u32 s64, s83, 49152
    buffer_load_dwordx4 v[152:155], v246, s[16:19], s64 offen offset:0 sc1
    v_exp_f32 v188, v40
    v_exp_f32 v189, v41
    v_exp_f32 v190, v42
    v_exp_f32 v191, v43
    v_smfmac_f32_32x32x32_bf16 v[64:79], v[180:183], v[32:39], v245
    ds_read_b64_tr_b16 v[180:181], v249 offset:53664
    ds_read_b64_tr_b16 v[182:183], v250 offset:53664
    v_exp_f32 v192, v44
    v_exp_f32 v193, v45
    s_add_u32 s64, s82, 4096
    buffer_load_dwordx4 v[160:163], v2, s[16:19], s64 offen offset:0 sc1
    v_exp_f32 v194, v46
    v_exp_f32 v195, v47
    v_mfma_f32_32x32x16_bf16 v[32:47], v[176:179], v[12:15], 0
    ds_read_b128 v[176:179], v248 offset:57792
    v_exp_f32 v16, v16
    v_exp_f32 v17, v17
    v_exp_f32 v18, v18
    v_smfmac_f32_32x32x32_bf16 v[64:79], v[184:187], v[188:195], v245
    ds_read_b64_tr_b16 v[184:185], v251 offset:53664
    ds_read_b64_tr_b16 v[186:187], v252 offset:53664
    v_exp_f32 v19, v19
    v_exp_f32 v20, v20
    v_exp_f32 v21, v21
    v_mfma_f32_32x32x16_bf16 v[112:127], v[168:171], v[164:167], v[112:127]
    s_add_u32 s64, s83, 65536
    buffer_load_dwordx4 v[172:175], v247, s[16:19], s64 offen offset:0 sc1
    v_exp_f32 v22, v22
    v_exp_f32 v23, v23
    v_exp_f32 v188, v24
    v_exp_f32 v189, v25
    s_waitcnt lgkmcnt(3)
    v_smfmac_f32_32x32x32_bf16 v[48:63], v[180:183], v[16:23], v245
    v_exp_f32 v190, v26
    v_exp_f32 v191, v27
    v_exp_f32 v192, v28
    s_waitcnt vmcnt(8)
    v_mfma_f32_32x32x16_bf16 v[80:95], v[204:207], v[196:199], v[80:95]
    s_add_u32 s64, s59, 4096
    buffer_load_dwordx4 v[164:167], v2, s[16:19], s64 offen offset:0 sc1
PAD20:
    s_cbranch_execz SC_BACK
    v_exp_f32 v193, v29
    v_exp_f32 v194, v30
    v_exp_f32 v195, v31
    s_waitcnt lgkmcnt(2)
    v_mfma_f32_32x32x16_bf16 v[16:31], v[176:179], v[8:11], 0
    v_exp_f32 v32, v32
    v_exp_f32 v33, v33
    v_exp_f32 v34, v34
    s_waitcnt lgkmcnt(0)
    v_smfmac_f32_32x32x32_bf16 v[48:63], v[184:187], v[188:195], v245
    v_exp_f32 v35, v35
    v_exp_f32 v36, v36
    v_exp_f32 v37, v37
    s_waitcnt vmcnt(8)
    v_mfma_f32_32x32x16_bf16 v[96:111], v[208:211], v[196:199], v[96:111]
    s_add_u32 s64, s83, 65536
    buffer_load_dwordx4 v[168:171], v246, s[16:19], s64 offen offset:0 sc1
    v_exp_f32 v38, v38
    v_exp_f32 v39, v39
    v_exp_f32 v188, v40
    v_exp_f32 v189, v41
    v_smfmac_f32_32x32x32_bf16 v[64:79], v[180:183], v[32:39], v245
    ds_read_b64_tr_b16 v[180:181], v249 offset:57792
    ds_read_b64_tr_b16 v[182:183], v250 offset:57792
    v_exp_f32 v190, v42
    v_exp_f32 v191, v43
    v_exp_f32 v192, v44
    s_waitcnt vmcnt(8)
    v_mfma_f32_32x32x16_bf16 v[128:143], v[208:211], v[200:203], v[128:143]
    s_add_u32 s64, s82, 5120
    buffer_load_dwordx4 v[196:199], v2, s[16:19], s64 offen offset:0 sc1
    v_exp_f32 v193, v45
    v_exp_f32 v194, v46
    v_exp_f32 v195, v47
    v_mfma_f32_32x32x16_bf16 v[32:47], v[176:179], v[12:15], 0
    ds_read_b128 v[176:179], v248 offset:61920
    v_exp_f32 v16, v16
    v_exp_f32 v17, v17
    v_exp_f32 v18, v18
    v_exp_f32 v19, v19
    v_smfmac_f32_32x32x32_bf16 v[64:79], v[184:187], v[188:195], v245
    ds_read_b64_tr_b16 v[184:185], v251 offset:57792
    ds_read_b64_tr_b16 v[186:187], v252 offset:57792
    v_exp_f32 v20, v20
    v_exp_f32 v21, v21
    v_exp_f32 v22, v22
    v_exp_f32 v23, v23
    v_mfma_f32_32x32x16_bf16 v[112:127], v[204:207], v[200:203], v[112:127]
    s_add_u32 s64, s83, 81920
    buffer_load_dwordx4 v[208:211], v247, s[16:19], s64 offen offset:0 sc1
    v_exp_f32 v188, v24
    v_exp_f32 v189, v25
    v_exp_f32 v190, v26
    v_exp_f32 v191, v27
    s_waitcnt lgkmcnt(3)
    v_smfmac_f32_32x32x32_bf16 v[48:63], v[180:183], v[16:23], v245
    v_exp_f32 v192, v28
    v_exp_f32 v193, v29
    s_add_u32 s64, s59, 5120
    buffer_load_dwordx4 v[200:203], v2, s[16:19], s64 offen offset:0 sc1
    v_exp_f32 v194, v30
    v_exp_f32 v195, v31
    s_waitcnt lgkmcnt(2)
    v_mfma_f32_32x32x16_bf16 v[16:31], v[176:179], v[8:11], 0
    v_exp_f32 v32, v32
    v_exp_f32 v33, v33
    v_exp_f32 v34, v34
    s_waitcnt lgkmcnt(0)
    v_smfmac_f32_32x32x32_bf16 v[48:63], v[184:187], v[188:195], v245
    v_exp_f32 v35, v35
    v_exp_f32 v36, v36
    v_exp_f32 v37, v37
    s_waitcnt vmcnt(7)
    v_mfma_f32_32x32x16_bf16 v[80:95], v[152:155], v[144:147], v[80:95]
    s_add_u32 s64, s83, 81920
    buffer_load_dwordx4 v[204:207], v246, s[16:19], s64 offen offset:0 sc1
    v_exp_f32 v38, v38
    v_exp_f32 v39, v39
    v_exp_f32 v188, v40
    v_exp_f32 v189, v41
    v_smfmac_f32_32x32x32_bf16 v[64:79], v[180:183], v[32:39], v245
    ds_read_b64_tr_b16 v[180:181], v249 offset:61920
    ds_read_b64_tr_b16 v[182:183], v250 offset:61920
    v_exp_f32 v190, v42
    v_exp_f32 v191, v43
    v_exp_f32 v192, v44
    v_mfma_f32_32x32x16_bf16 v[96:111], v[156:159], v[144:147], v[96:111]
    s_add_u32 s64, s82, 6144
    buffer_load_dwordx4 v[144:147], v2, s[16:19], s64 offen offset:0 sc1
    v_exp_f32 v193, v45
    v_exp_f32 v194, v46
    v_exp_f32 v195, v47
    v_mfma_f32_32x32x16_bf16 v[32:47], v[176:179], v[12:15], 0
    v_add_u32 v248, 66048, v248
    ds_read_b128 v[176:179], v248 offset:0
    v_exp_f32 v16, v16
    v_exp_f32 v17, v17
    v_exp_f32 v18, v18
    v_smfmac_f32_32x32x32_bf16 v[64:79], v[184:187], v[188:195], v245
    ds_read_b64_tr_b16 v[184:185], v251 offset:61920
    ds_read_b64_tr_b16 v[186:187], v252 offset:61920
    v_exp_f32 v19, v19
    v_exp_f32 v20, v20
    v_exp_f32 v21, v21
    v_mfma_f32_32x32x16_bf16 v[128:143], v[156:159], v[148:151], v[128:143]
    s_add_u32 s64, s83, 98304
    buffer_load_dwordx4 v[156:159], v247, s[16:19], s64 offen offset:0 sc1
    v_exp_f32 v22, v22
    v_exp_f32 v23, v23
    v_exp_f32 v188, v24
    v_exp_f32 v189, v25
    s_waitcnt lgkmcnt(3)
    v_smfmac_f32_32x32x32_bf16 v[48:63], v[180:183], v[16:23], v245
    v_exp_f32 v190, v26
    v_exp_f32 v191, v27
    v_exp_f32 v192, v28
    v_mfma_f32_32x32x16_bf16 v[112:127], v[152:155], v[148:151], v[112:127]
    s_add_u32 s64, s59, 6144
    buffer_load_dwordx4 v[148:151], v2, s[16:19], s64 offen offset:0 sc1
    v_exp_f32 v193, v29
    v_exp_f32 v194, v30
    v_exp_f32 v195, v31
    s_waitcnt lgkmcnt(2)
    v_mfma_f32_32x32x16_bf16 v[16:31], v[176:179], v[8:11], 0
    v_exp_f32 v32, v32
    v_exp_f32 v33, v33
    v_exp_f32 v34, v34
    v_exp_f32 v35, v35
    s_waitcnt lgkmcnt(0)
    v_smfmac_f32_32x32x32_bf16 v[48:63], v[184:187], v[188:195], v245
    v_exp_f32 v36, v36
    v_exp_f32 v37, v37
    v_exp_f32 v38, v38
    v_exp_f32 v39, v39
    s_waitcnt vmcnt(7)
    v_mfma_f32_32x32x16_bf16 v[80:95], v[168:171], v[160:163], v[80:95]
    s_add_u32 s64, s83, 98304
    buffer_load_dwordx4 v[152:155], v246, s[16:19], s64 offen offset:0 sc1
    v_exp_f32 v188, v40
    v_exp_f32 v189, v41
    v_exp_f32 v190, v42
    v_exp_f32 v191, v43
    v_smfmac_f32_32x32x32_bf16 v[64:79], v[180:183], v[32:39], v245
    v_add_u32 v249, 66048, v249
    ds_read_b64_tr_b16 v[180:181], v249 offset:0
    v_add_u32 v250, 66048, v250
    ds_read_b64_tr_b16 v[182:183], v250 offset:0
    v_exp_f32 v192, v44
    v_exp_f32 v193, v45
    v_exp_f32 v194, v46
    v_exp_f32 v195, v47
    v_mfma_f32_32x32x16_bf16 v[32:47], v[176:179], v[12:15], 0
    ds_read_b128 v[176:179], v248 offset:4128
    v_mov_b32 v255, 32
    ds_write_b32 v253, v255
    ds_read_b32 v255, v254
    v_exp_f32 v16, v16
    v_exp_f32 v17, v17
    v_exp_f32 v18, v18
    v_smfmac_f32_32x32x32_bf16 v[64:79], v[184:187], v[188:195], v245
    v_add_u32 v251, 66048, v251
    ds_read_b64_tr_b16 v[184:185], v251 offset:0
    v_add_u32 v252, 66048, v252
    ds_read_b64_tr_b16 v[186:187], v252 offset:0
    v_exp_f32 v19, v19
    v_exp_f32 v20, v20
    v_exp_f32 v21, v21
    v_mfma_f32_32x32x16_bf16 v[96:111], v[172:175], v[160:163], v[96:111]
    s_add_u32 s64, s82, 7168
    buffer_load_dwordx4 v[160:163], v2, s[16:19], s64 offen offset:0 sc1
    v_exp_f32 v22, v22
    v_exp_f32 v23, v23
    v_exp_f32 v188, v24
    v_exp_f32 v189, v25
    s_waitcnt lgkmcnt(5)
    v_smfmac_f32_32x32x32_bf16 v[48:63], v[180:183], v[16:23], v245
    v_exp_f32 v190, v26
    v_exp_f32 v191, v27
    v_exp_f32 v192, v28
    v_mfma_f32_32x32x16_bf16 v[128:143], v[172:175], v[164:167], v[128:143]
    s_add_u32 s64, s83, 114688
    buffer_load_dwordx4 v[172:175], v247, s[16:19], s64 offen offset:0 sc1
    v_exp_f32 v193, v29
    v_exp_f32 v194, v30
    v_exp_f32 v195, v31
    s_waitcnt lgkmcnt(4)
    v_mfma_f32_32x32x16_bf16 v[16:31], v[176:179], v[8:11], 0
    v_exp_f32 v32, v32
    v_exp_f32 v33, v33
    v_exp_f32 v34, v34
    s_waitcnt lgkmcnt(0)
    v_smfmac_f32_32x32x32_bf16 v[48:63], v[184:187], v[188:195], v245
    v_exp_f32 v35, v35
    v_readfirstlane_b32 s65, v255
    v_exp_f32 v36, v36
    v_exp_f32 v37, v37
    v_mfma_f32_32x32x16_bf16 v[112:127], v[168:171], v[164:167], v[112:127]
PAD21:
    s_cbranch_execz SC_BACK
    s_add_u32 s64, s59, 7168
    buffer_load_dwordx4 v[164:167], v2, s[16:19], s64 offen offset:0 sc1
    v_exp_f32 v38, v38
    v_exp_f32 v39, v39
    s_cmp_ge_u32 s65, 32
    s_cbranch_scc0 PL_28
    s_setprio 1
    s_branch PD_29
PL_28:
    s_setprio 0
PD_29:
    v_exp_f32 v188, v40
    v_exp_f32 v189, v41
    v_smfmac_f32_32x32x32_bf16 v[64:79], v[180:183], v[32:39], v245
    ds_read_b64_tr_b16 v[180:181], v249 offset:4128
    ds_read_b64_tr_b16 v[182:183], v250 offset:4128
    v_exp_f32 v190, v42
    v_exp_f32 v191, v43
    v_exp_f32 v192, v44
    s_waitcnt vmcnt(7)
    v_mfma_f32_32x32x16_bf16 v[80:95], v[204:207], v[196:199], v[80:95]
    s_add_u32 s64, s83, 114688
    buffer_load_dwordx4 v[168:171], v246, s[16:19], s64 offen offset:0 sc1
    v_exp_f32 v193, v45
    v_exp_f32 v194, v46
    v_exp_f32 v195, v47
    v_mfma_f32_32x32x16_bf16 v[32:47], v[176:179], v[12:15], 0
    ds_read_b128 v[176:179], v248 offset:8256
    v_exp_f32 v16, v16
    v_exp_f32 v17, v17
    v_exp_f32 v18, v18
    v_smfmac_f32_32x32x32_bf16 v[64:79], v[184:187], v[188:195], v245
    ds_read_b64_tr_b16 v[184:185], v251 offset:4128
    ds_read_b64_tr_b16 v[186:187], v252 offset:4128
    v_exp_f32 v19, v19
    v_exp_f32 v20, v20
    v_exp_f32 v21, v21
    v_mfma_f32_32x32x16_bf16 v[96:111], v[208:211], v[196:199], v[96:111]
    s_add_u32 s64, s82, 8192
    buffer_load_dwordx4 v[196:199], v2, s[16:19], s64 offen offset:0 sc1
    v_exp_f32 v22, v22
    v_exp_f32 v23, v23
    v_exp_f32 v188, v24
    v_exp_f32 v189, v25
    s_waitcnt lgkmcnt(3)
    v_smfmac_f32_32x32x32_bf16 v[48:63], v[180:183], v[16:23], v245
    v_exp_f32 v190, v26
    v_exp_f32 v191, v27
    v_exp_f32 v192, v28
    v_mfma_f32_32x32x16_bf16 v[128:143], v[208:211], v[200:203], v[128:143]
    s_add_u32 s64, s83, 131072
    buffer_load_dwordx4 v[208:211], v247, s[16:19], s64 offen offset:0 sc1
    v_exp_f32 v193, v29
    v_exp_f32 v194, v30
    v_exp_f32 v195, v31
    s_waitcnt lgkmcnt(2)
    v_mfma_f32_32x32x16_bf16 v[16:31], v[176:179], v[8:11], 0
    v_exp_f32 v32, v32
    v_exp_f32 v33, v33
    v_exp_f32 v34, v34
    v_exp_f32 v35, v35
    s_waitcnt lgkmcnt(0)
    v_smfmac_f32_32x32x32_bf16 v[48:63], v[184:187], v[188:195], v245
    v_exp_f32 v36, v36
    v_exp_f32 v37, v37
    v_exp_f32 v38, v38
    v_exp_f32 v39, v39
    v_mfma_f32_32x32x16_bf16 v[112:127], v[204:207], v[200:203], v[112:127]
    s_add_u32 s64, s59, 8192
    buffer_load_dwordx4 v[200:203], v2, s[16:19], s64 offen offset:0 sc1
    v_exp_f32 v188, v40
    v_exp_f32 v189, v41
    v_exp_f32 v190, v42
    v_exp_f32 v191, v43
    v_smfmac_f32_32x32x32_bf16 v[64:79], v[180:183], v[32:39], v245
    ds_read_b64_tr_b16 v[180:181], v249 offset:8256
    ds_read_b64_tr_b16 v[182:183], v250 offset:8256
    v_exp_f32 v192, v44
    v_exp_f32 v193, v45
    s_add_u32 s64, s83, 131072
    buffer_load_dwordx4 v[204:207], v246, s[16:19], s64 offen offset:0 sc1
    v_exp_f32 v194, v46
    v_exp_f32 v195, v47
    v_mfma_f32_32x32x16_bf16 v[32:47], v[176:179], v[12:15], 0
    ds_read_b128 v[176:179], v248 offset:12384
    v_exp_f32 v16, v16
    v_exp_f32 v17, v17
    v_exp_f32 v18, v18
    v_smfmac_f32_32x32x32_bf16 v[64:79], v[184:187], v[188:195], v245
    ds_read_b64_tr_b16 v[184:185], v251 offset:8256
    ds_read_b64_tr_b16 v[186:187], v252 offset:8256
    v_exp_f32 v19, v19
    v_exp_f32 v20, v20
    v_exp_f32 v21, v21
    s_waitcnt vmcnt(8)
    v_mfma_f32_32x32x16_bf16 v[80:95], v[152:155], v[144:147], v[80:95]
    v_exp_f32 v22, v22
    v_exp_f32 v23, v23
    v_exp_f32 v188, v24
    v_exp_f32 v189, v25
    s_waitcnt lgkmcnt(3)
    v_smfmac_f32_32x32x32_bf16 v[48:63], v[180:183], v[16:23], v245
    v_exp_f32 v190, v26
    v_exp_f32 v191, v27
    v_exp_f32 v192, v28
    v_mfma_f32_32x32x16_bf16 v[96:111], v[156:159], v[144:147], v[96:111]
    s_add_u32 s64, s82, 9216
    buffer_load_dwordx4 v[144:147], v2, s[16:19], s64 offen offset:0 sc1
    v_exp_f32 v193, v29
    v_exp_f32 v194, v30
    v_exp_f32 v195, v31
    s_waitcnt lgkmcnt(2)
    v_mfma_f32_32x32x16_bf16 v[16:31], v[176:179], v[8:11], 0
    v_exp_f32 v32, v32
    v_exp_f32 v33, v33
    v_exp_f32 v34, v34
    s_waitcnt lgkmcnt(0)
    v_smfmac_f32_32x32x32_bf16 v[48:63], v[184:187], v[188:195], v245
    v_exp_f32 v35, v35
    v_exp_f32 v36, v36
    v_exp_f32 v37, v37
    v_mfma_f32_32x32x16_bf16 v[128:143], v[156:159], v[148:151], v[128:143]
    s_add_u32 s64, s83, 147456
    buffer_load_dwordx4 v[156:159], v247, s[16:19], s64 offen offset:0 sc1
    v_exp_f32 v38, v38
    v_exp_f32 v39, v39
    v_exp_f32 v188, v40
    v_exp_f32 v189, v41
    v_smfmac_f32_32x32x32_bf16 v[64:79], v[180:183], v[32:39], v245
    ds_read_b64_tr_b16 v[180:181], v249 offset:12384
    ds_read_b64_tr_b16 v[182:183], v250 offset:12384
    v_exp_f32 v190, v42
    v_exp_f32 v191, v43
    v_exp_f32 v192, v44
    v_mfma_f32_32x32x16_bf16 v[112:127], v[152:155], v[148:151], v[112:127]
    s_add_u32 s64, s59, 9216
    buffer_load_dwordx4 v[148:151], v2, s[16:19], s64 offen offset:0 sc1
    v_exp_f32 v193, v45
    v_exp_f32 v194, v46
    v_exp_f32 v195, v47
    v_mfma_f32_32x32x16_bf16 v[32:47], v[176:179], v[12:15], 0
    ds_read_b128 v[176:179], v248 offset:16512
    v_exp_f32 v16, v16
    v_exp_f32 v17, v17
    v_exp_f32 v18, v18
    v_exp_f32 v19, v19
    v_smfmac_f32_32x32x32_bf16 v[64:79], v[184:187], v[188:195], v245
    ds_read_b64_tr_b16 v[184:185], v251 offset:12384
    ds_read_b64_tr_b16 v[186:187], v252 offset:12384
    v_exp_f32 v20, v20
    v_exp_f32 v21, v21
    v_exp_f32 v22, v22
    v_exp_f32 v23, v23
    s_waitcnt vmcnt(7)
    v_mfma_f32_32x32x16_bf16 v[80:95], v[168:171], v[160:163], v[80:95]
    s_add_u32 s64, s83, 147456
    buffer_load_dwordx4 v[152:155], v246, s[16:19], s64 offen offset:0 sc1
    v_exp_f32 v188, v24
    v_exp_f32 v189, v25
    v_exp_f32 v190, v26
    v_exp_f32 v191, v27
    s_waitcnt lgkmcnt(3)
    v_smfmac_f32_32x32x32_bf16 v[48:63], v[180:183], v[16:23], v245
    v_exp_f32 v192, v28
    v_exp_f32 v193, v29
    v_exp_f32 v194, v30
    v_exp_f32 v195, v31
    s_waitcnt lgkmcnt(2)
    v_mfma_f32_32x32x16_bf16 v[16:31], v[176:179], v[8:11], 0
    v_exp_f32 v32, v32
    v_exp_f32 v33, v33
    v_exp_f32 v34, v34
    s_waitcnt lgkmcnt(0)
    v_smfmac_f32_32x32x32_bf16 v[48:63], v[184:187], v[188:195], v245
    v_exp_f32 v35, v35
    v_exp_f32 v36, v36
    v_exp_f32 v37, v37
    v_mfma_f32_32x32x16_bf16 v[96:111], v[172:175], v[160:163], v[96:111]
    s_add_u32 s64, s82, 10240
    buffer_load_dwordx4 v[160:163], v2, s[16:19], s64 offen offset:0 sc1
    v_exp_f32 v38, v38
    v_exp_f32 v39, v39
    v_exp_f32 v188, v40
    v_exp_f32 v189, v41
    v_smfmac_f32_32x32x32_bf16 v[64:79], v[180:183], v[32:39], v245
    ds_read_b64_tr_b16 v[180:181], v249 offset:16512
    ds_read_b64_tr_b16 v[182:183], v250 offset:16512
    v_exp_f32 v190, v42
    v_exp_f32 v191, v43
    v_exp_f32 v192, v44
    v_mfma_f32_32x32x16_bf16 v[128:143], v[172:175], v[164:167], v[128:143]
    s_add_u32 s64, s83, 163840
    buffer_load_dwordx4 v[172:175], v247, s[16:19], s64 offen offset:0 sc1
    v_exp_f32 v193, v45
    v_exp_f32 v194, v46
    v_exp_f32 v195, v47
    v_mfma_f32_32x32x16_bf16 v[32:47], v[176:179], v[12:15], 0
    ds_read_b128 v[176:179], v248 offset:20640
    v_mov_b32 v255, 40
PAD22:
    s_cbranch_execz SC_BACK
    ds_write_b32 v253, v255
    ds_read_b32 v255, v254
    v_exp_f32 v16, v16
    v_exp_f32 v17, v17
    v_exp_f32 v18, v18
    v_smfmac_f32_32x32x32_bf16 v[64:79], v[184:187], v[188:195], v245
    ds_read_b64_tr_b16 v[184:185], v251 offset:16512
    ds_read_b64_tr_b16 v[186:187], v252 offset:16512
    v_exp_f32 v19, v19
    v_exp_f32 v20, v20
    v_exp_f32 v21, v21
    v_mfma_f32_32x32x16_bf16 v[112:127], v[168:171], v[164:167], v[112:127]
    s_add_u32 s64, s59, 10240
    buffer_load_dwordx4 v[164:167], v2, s[16:19], s64 offen offset:0 sc1
    v_exp_f32 v22, v22
    v_exp_f32 v23, v23
    v_exp_f32 v188, v24
    v_exp_f32 v189, v25
    s_waitcnt lgkmcnt(5)
    v_smfmac_f32_32x32x32_bf16 v[48:63], v[180:183], v[16:23], v245
    v_exp_f32 v190, v26
    v_exp_f32 v191, v27
    v_exp_f32 v192, v28
    s_waitcnt vmcnt(7)
    v_mfma_f32_32x32x16_bf16 v[80:95], v[204:207], v[196:199], v[80:95]
    s_add_u32 s64, s83, 163840
    buffer_load_dwordx4 v[168:171], v246, s[16:19], s64 offen offset:0 sc1
    v_exp_f32 v193, v29
    v_exp_f32 v194, v30
    v_exp_f32 v195, v31
    s_waitcnt lgkmcnt(4)
    v_mfma_f32_32x32x16_bf16 v[16:31], v[176:179], v[8:11], 0
    v_exp_f32 v32, v32
    v_exp_f32 v33, v33
    v_exp_f32 v34, v34
    v_exp_f32 v35, v35
    s_waitcnt lgkmcnt(0)
    v_smfmac_f32_32x32x32_bf16 v[48:63], v[184:187], v[188:195], v245
    v_readfirstlane_b32 s65, v255
    v_exp_f32 v36, v36
    v_exp_f32 v37, v37
    v_exp_f32 v38, v38
    v_exp_f32 v39, v39
    s_cmp_ge_u32 s65, 40
    s_cbranch_scc0 PL_30
    s_setprio 1
    s_branch PD_31
PL_30:
    s_setprio 0
PD_31:
    v_mfma_f32_32x32x16_bf16 v[96:111], v[208:211], v[196:199], v[96:111]
    s_add_u32 s64, s82, 11264
    buffer_load_dwordx4 v[196:199], v2, s[16:19], s64 offen offset:0 sc1
    v_exp_f32 v188, v40
    v_exp_f32 v189, v41
    v_exp_f32 v190, v42
    v_exp_f32 v191, v43
    v_smfmac_f32_32x32x32_bf16 v[64:79], v[180:183], v[32:39], v245
    ds_read_b64_tr_b16 v[180:181], v249 offset:20640
    ds_read_b64_tr_b16 v[182:183], v250 offset:20640
    v_exp_f32 v192, v44
    v_exp_f32 v193, v45
    v_exp_f32 v194, v46
    v_exp_f32 v195, v47
    v_mfma_f32_32x32x16_bf16 v[32:47], v[176:179], v[12:15], 0
    ds_read_b128 v[176:179], v248 offset:24768
    v_exp_f32 v16, v16
    v_exp_f32 v17, v17
    v_exp_f32 v18, v18
    v_smfmac_f32_32x32x32_bf16 v[64:79], v[184:187], v[188:195], v245
    ds_read_b64_tr_b16 v[184:185], v251 offset:20640
    ds_read_b64_tr_b16 v[186:187], v252 offset:20640
    v_exp_f32 v19, v19
    v_exp_f32 v20, v20
    v_exp_f32 v21, v21
    v_mfma_f32_32x32x16_bf16 v[128:143], v[208:211], v[200:203], v[128:143]
    s_add_u32 s64, s83, 180224
    buffer_load_dwordx4 v[208:211], v247, s[16:19], s64 offen offset:0 sc1
    v_exp_f32 v22, v22
    v_exp_f32 v23, v23
    v_exp_f32 v188, v24
    v_exp_f32 v189, v25
    s_waitcnt lgkmcnt(3)
    v_smfmac_f32_32x32x32_bf16 v[48:63], v[180:183], v[16:23], v245
    v_exp_f32 v190, v26
    v_exp_f32 v191, v27
    v_exp_f32 v192, v28
    v_mfma_f32_32x32x16_bf16 v[112:127], v[204:207], v[200:203], v[112:127]
    s_add_u32 s64, s59, 11264
    buffer_load_dwordx4 v[200:203], v2, s[16:19], s64 offen offset:0 sc1
    v_exp_f32 v193, v29
    v_exp_f32 v194, v30
    v_exp_f32 v195, v31
    s_waitcnt lgkmcnt(2)
    v_mfma_f32_32x32x16_bf16 v[16:31], v[176:179], v[8:11], 0
    v_exp_f32 v32, v32
    v_exp_f32 v33, v33
    v_exp_f32 v34, v34
    s_waitcnt lgkmcnt(0)
    v_smfmac_f32_32x32x32_bf16 v[48:63], v[184:187], v[188:195], v245
    v_exp_f32 v35, v35
    v_exp_f32 v36, v36
    v_exp_f32 v37, v37
    s_waitcnt vmcnt(7)
    v_mfma_f32_32x32x16_bf16 v[80:95], v[152:155], v[144:147], v[80:95]
    s_add_u32 s64, s83, 180224
    buffer_load_dwordx4 v[204:207], v246, s[16:19], s64 offen offset:0 sc1
    v_exp_f32 v38, v38
    v_exp_f32 v39, v39
    v_exp_f32 v188, v40
    v_exp_f32 v189, v41
    v_smfmac_f32_32x32x32_bf16 v[64:79], v[180:183], v[32:39], v245
    ds_read_b64_tr_b16 v[180:181], v249 offset:24768
    ds_read_b64_tr_b16 v[182:183], v250 offset:24768
    v_exp_f32 v190, v42
    v_exp_f32 v191, v43
    v_exp_f32 v192, v44
    v_mfma_f32_32x32x16_bf16 v[96:111], v[156:159], v[144:147], v[96:111]
    s_add_u32 s64, s82, 12288
    buffer_load_dwordx4 v[144:147], v2, s[16:19], s64 offen offset:0 sc1
    v_exp_f32 v193, v45
    v_exp_f32 v194, v46
    v_exp_f32 v195, v47
    v_mfma_f32_32x32x16_bf16 v[32:47], v[176:179], v[12:15], 0
    ds_read_b128 v[176:179], v248 offset:28896
    v_exp_f32 v16, v16
    v_exp_f32 v17, v17
    v_exp_f32 v18, v18
    v_smfmac_f32_32x32x32_bf16 v[64:79], v[184:187], v[188:195], v245
    ds_read_b64_tr_b16 v[184:185], v251 offset:24768
    ds_read_b64_tr_b16 v[186:187], v252 offset:24768
    v_exp_f32 v19, v19
    v_exp_f32 v20, v20
    v_exp_f32 v21, v21
    v_mfma_f32_32x32x16_bf16 v[128:143], v[156:159], v[148:151], v[128:143]
    s_add_u32 s64, s83, 196608
    buffer_load_dwordx4 v[156:159], v247, s[16:19], s64 offen offset:0 sc1
    v_exp_f32 v22, v22
    v_exp_f32 v23, v23
    v_exp_f32 v188, v24
    v_exp_f32 v189, v25
    s_waitcnt lgkmcnt(3)
    v_smfmac_f32_32x32x32_bf16 v[48:63], v[180:183], v[16:23], v245
    v_exp_f32 v190, v26
    v_exp_f32 v191, v27
    v_exp_f32 v192, v28
    v_mfma_f32_32x32x16_bf16 v[112:127], v[152:155], v[148:151], v[112:127]
    s_add_u32 s64, s59, 12288
    buffer_load_dwordx4 v[148:151], v2, s[16:19], s64 offen offset:0 sc1
    v_exp_f32 v193, v29
    v_exp_f32 v194, v30
    v_exp_f32 v195, v31
    s_waitcnt lgkmcnt(2)
    v_mfma_f32_32x32x16_bf16 v[16:31], v[176:179], v[8:11], 0
PAD23:
    s_cbranch_execz SC_BACK
QAD7:
    s_cbranch_execz VRET
    v_exp_f32 v32, v32
    v_exp_f32 v33, v33
    v_exp_f32 v34, v34
    v_exp_f32 v35, v35
    s_waitcnt lgkmcnt(0)
    v_smfmac_f32_32x32x32_bf16 v[48:63], v[184:187], v[188:195], v245
    v_exp_f32 v36, v36
    v_exp_f32 v37, v37
    v_exp_f32 v38, v38
    v_exp_f32 v39, v39
    s_waitcnt vmcnt(7)
    v_mfma_f32_32x32x16_bf16 v[80:95], v[168:171], v[160:163], v[80:95]
    s_add_u32 s64, s83, 196608
    buffer_load_dwordx4 v[152:155], v246, s[16:19], s64 offen offset:0 sc1
    v_exp_f32 v188, v40
    v_exp_f32 v189, v41
    v_exp_f32 v190, v42
    v_exp_f32 v191, v43
    v_smfmac_f32_32x32x32_bf16 v[64:79], v[180:183], v[32:39], v245
    ds_read_b64_tr_b16 v[180:181], v249 offset:28896
    ds_read_b64_tr_b16 v[182:183], v250 offset:28896
    v_exp_f32 v192, v44
    v_exp_f32 v193, v45
    v_exp_f32 v194, v46
    v_exp_f32 v195, v47
    v_mfma_f32_32x32x16_bf16 v[32:47], v[176:179], v[12:15], 0
    ds_read_b128 v[176:179], v248 offset:33024
    v_exp_f32 v16, v16
    v_exp_f32 v17, v17
    v_exp_f32 v18, v18
    v_smfmac_f32_32x32x32_bf16 v[64:79], v[184:187], v[188:195], v245
    ds_read_b64_tr_b16 v[184:185], v251 offset:28896
    ds_read_b64_tr_b16 v[186:187], v252 offset:28896
    v_exp_f32 v19, v19
    v_exp_f32 v20, v20
    v_exp_f32 v21, v21
    v_mfma_f32_32x32x16_bf16 v[96:111], v[172:175], v[160:163], v[96:111]
    s_add_u32 s64, s82, 13312
    buffer_load_dwordx4 v[160:163], v2, s[16:19], s64 offen offset:0 sc1
    v_exp_f32 v22, v22
    v_exp_f32 v23, v23
    v_exp_f32 v188, v24
    v_exp_f32 v189, v25
    s_waitcnt lgkmcnt(3)
    v_smfmac_f32_32x32x32_bf16 v[48:63], v[180:183], v[16:23], v245
    v_exp_f32 v190, v26
    v_exp_f32 v191, v27
    v_exp_f32 v192, v28
    v_mfma_f32_32x32x16_bf16 v[128:143], v[172:175], v[164:167], v[128:143]
    s_add_u32 s64, s83, 212992
    buffer_load_dwordx4 v[172:175], v247, s[16:19], s64 offen offset:0 sc1
    v_exp_f32 v193, v29
    v_exp_f32 v194, v30
    v_exp_f32 v195, v31
    s_waitcnt lgkmcnt(2)
    v_mfma_f32_32x32x16_bf16 v[16:31], v[176:179], v[8:11], 0
    v_exp_f32 v32, v32
    v_exp_f32 v33, v33
    v_exp_f32 v34, v34
    s_waitcnt lgkmcnt(0)
    v_smfmac_f32_32x32x32_bf16 v[48:63], v[184:187], v[188:195], v245
    v_exp_f32 v35, v35
    v_exp_f32 v36, v36
    v_exp_f32 v37, v37
    v_mfma_f32_32x32x16_bf16 v[112:127], v[168:171], v[164:167], v[112:127]
    s_add_u32 s64, s59, 13312
    buffer_load_dwordx4 v[164:167], v2, s[16:19], s64 offen offset:0 sc1
    v_exp_f32 v38, v38
    v_exp_f32 v39, v39
    v_exp_f32 v188, v40
    v_exp_f32 v189, v41
    v_smfmac_f32_32x32x32_bf16 v[64:79], v[180:183], v[32:39], v245
    ds_read_b64_tr_b16 v[180:181], v249 offset:33024
    ds_read_b64_tr_b16 v[182:183], v250 offset:33024
    v_exp_f32 v190, v42
    v_exp_f32 v191, v43
    v_exp_f32 v192, v44
    s_waitcnt vmcnt(7)
    v_mfma_f32_32x32x16_bf16 v[80:95], v[204:207], v[196:199], v[80:95]
    s_add_u32 s64, s83, 212992
    buffer_load_dwordx4 v[168:171], v246, s[16:19], s64 offen offset:0 sc1
    v_exp_f32 v193, v45
    v_exp_f32 v194, v46
    v_exp_f32 v195, v47
    v_mfma_f32_32x32x16_bf16 v[32:47], v[176:179], v[12:15], 0
    ds_read_b128 v[176:179], v248 offset:37152
    v_mov_b32 v255, 48
    ds_write_b32 v253, v255
    ds_read_b32 v255, v254
    v_exp_f32 v16, v16
    v_exp_f32 v17, v17
    v_exp_f32 v18, v18
    v_exp_f32 v19, v19
    v_smfmac_f32_32x32x32_bf16 v[64:79], v[184:187], v[188:195], v245
    ds_read_b64_tr_b16 v[184:185], v251 offset:33024
    ds_read_b64_tr_b16 v[186:187], v252 offset:33024
    v_exp_f32 v20, v20
    v_exp_f32 v21, v21
    v_exp_f32 v22, v22
    v_exp_f32 v23, v23
    v_mfma_f32_32x32x16_bf16 v[96:111], v[208:211], v[196:199], v[96:111]
    buffer_load_dwordx4 v[196:199], v246, s[16:19], s48 offen offset:0 sc1
    v_exp_f32 v188, v24
    v_exp_f32 v189, v25
    v_exp_f32 v190, v26
    v_exp_f32 v191, v27
    s_waitcnt lgkmcnt(5)
    v_smfmac_f32_32x32x32_bf16 v[48:63], v[180:183], v[16:23], v245
    v_exp_f32 v192, v28
    v_exp_f32 v193, v29
    v_exp_f32 v194, v30
    v_exp_f32 v195, v31
    s_waitcnt lgkmcnt(4)
    v_mfma_f32_32x32x16_bf16 v[16:31], v[176:179], v[8:11], 0
    v_exp_f32 v32, v32
    v_exp_f32 v33, v33
    v_exp_f32 v34, v34
    s_waitcnt lgkmcnt(0)
    v_smfmac_f32_32x32x32_bf16 v[48:63], v[184:187], v[188:195], v245
    v_exp_f32 v35, v35
    v_readfirstlane_b32 s65, v255
    v_exp_f32 v36, v36
    v_exp_f32 v37, v37
    v_mfma_f32_32x32x16_bf16 v[128:143], v[208:211], v[200:203], v[128:143]
    buffer_load_dwordx4 v[208:211], v247, s[16:19], s48 offen offset:0 sc1
    v_exp_f32 v38, v38
    v_exp_f32 v39, v39
    s_cmp_ge_u32 s65, 48
    s_cbranch_scc0 PL_32
    s_setprio 1
    s_branch PD_33
PL_32:
    s_setprio 0
PD_33:
    v_exp_f32 v188, v40
    v_exp_f32 v189, v41
    v_smfmac_f32_32x32x32_bf16 v[64:79], v[180:183], v[32:39], v245
    ds_read_b64_tr_b16 v[180:181], v249 offset:37152
    ds_read_b64_tr_b16 v[182:183], v250 offset:37152
    v_exp_f32 v190, v42
    v_exp_f32 v191, v43
    v_exp_f32 v192, v44
    v_mfma_f32_32x32x16_bf16 v[112:127], v[204:207], v[200:203], v[112:127]
    s_xor_b32 s64, s48, 16384
    buffer_load_dwordx4 v[200:203], v246, s[16:19], s64 offen offset:0 sc1
    v_exp_f32 v193, v45
    v_exp_f32 v194, v46
    v_exp_f32 v195, v47
    v_mfma_f32_32x32x16_bf16 v[32:47], v[176:179], v[12:15], 0
    ds_read_b128 v[176:179], v248 offset:41280
    v_exp_f32 v16, v16
    v_exp_f32 v17, v17
    v_exp_f32 v18, v18
    v_smfmac_f32_32x32x32_bf16 v[64:79], v[184:187], v[188:195], v245
    ds_read_b64_tr_b16 v[184:185], v251 offset:37152
    ds_read_b64_tr_b16 v[186:187], v252 offset:37152
    v_exp_f32 v19, v19
    v_exp_f32 v20, v20
    v_exp_f32 v21, v21
    s_waitcnt vmcnt(7)
    v_mfma_f32_32x32x16_bf16 v[80:95], v[152:155], v[144:147], v[80:95]
    s_xor_b32 s64, s48, 16384
    buffer_load_dwordx4 v[204:207], v247, s[16:19], s64 offen offset:0 sc1
    v_exp_f32 v22, v22
    v_exp_f32 v23, v23
    v_exp_f32 v188, v24
    v_exp_f32 v189, v25
    s_waitcnt lgkmcnt(3)
    v_smfmac_f32_32x32x32_bf16 v[48:63], v[180:183], v[16:23], v245
    v_exp_f32 v190, v26
    v_exp_f32 v191, v27
    v_exp_f32 v192, v28
    v_mfma_f32_32x32x16_bf16 v[96:111], v[156:159], v[144:147], v[96:111]
    s_xor_b32 s64, s48, 32768
    buffer_load_dwordx4 v[144:147], v246, s[16:19], s64 offen offset:0 sc1
    v_exp_f32 v193, v29
    v_exp_f32 v194, v30
    v_exp_f32 v195, v31
    s_waitcnt lgkmcnt(2)
    v_mfma_f32_32x32x16_bf16 v[16:31], v[176:179], v[8:11], 0
    v_exp_f32 v32, v32
    v_exp_f32 v33, v33
    v_exp_f32 v34, v34
    v_exp_f32 v35, v35
    s_waitcnt lgkmcnt(0)
    v_smfmac_f32_32x32x32_bf16 v[48:63], v[184:187], v[188:195], v245
    v_exp_f32 v36, v36
    v_exp_f32 v37, v37
    v_exp_f32 v38, v38
    v_exp_f32 v39, v39
    v_mfma_f32_32x32x16_bf16 v[128:143], v[156:159], v[148:151], v[128:143]
    s_xor_b32 s64, s48, 32768
    buffer_load_dwordx4 v[156:159], v247, s[16:19], s64 offen offset:0 sc1
    v_exp_f32 v188, v40
    v_exp_f32 v189, v41
    v_exp_f32 v190, v42
    v_exp_f32 v191, v43
    v_smfmac_f32_32x32x32_bf16 v[64:79], v[180:183], v[32:39], v245
    ds_read_b64_tr_b16 v[180:181], v249 offset:41280
    ds_read_b64_tr_b16 v[182:183], v250 offset:41280
    v_exp_f32 v192, v44
PAD24:
    s_cbranch_execz SC_BACK
    v_exp_f32 v193, v45
    v_exp_f32 v194, v46
    v_exp_f32 v195, v47
    v_mfma_f32_32x32x16_bf16 v[32:47], v[176:179], v[12:15], 0
    ds_read_b128 v[176:179], v248 offset:45408
    v_exp_f32 v16, v16
    v_exp_f32 v17, v17
    v_exp_f32 v18, v18
    v_smfmac_f32_32x32x32_bf16 v[64:79], v[184:187], v[188:195], v245
    ds_read_b64_tr_b16 v[184:185], v251 offset:41280
    ds_read_b64_tr_b16 v[186:187], v252 offset:41280
    v_exp_f32 v19, v19
    v_exp_f32 v20, v20
    v_exp_f32 v21, v21
    v_mfma_f32_32x32x16_bf16 v[112:127], v[152:155], v[148:151], v[112:127]
    s_xor_b32 s64, s48, 49152
    buffer_load_dwordx4 v[148:151], v246, s[16:19], s64 offen offset:0 sc1
    v_exp_f32 v22, v22
    v_exp_f32 v23, v23
    v_exp_f32 v188, v24
    v_exp_f32 v189, v25
    s_waitcnt lgkmcnt(3)
    v_smfmac_f32_32x32x32_bf16 v[48:63], v[180:183], v[16:23], v245
    v_exp_f32 v190, v26
    v_exp_f32 v191, v27
    v_exp_f32 v192, v28
    s_waitcnt vmcnt(7)
    v_mfma_f32_32x32x16_bf16 v[80:95], v[168:171], v[160:163], v[80:95]
    s_xor_b32 s64, s48, 49152
    buffer_load_dwordx4 v[152:155], v247, s[16:19], s64 offen offset:0 sc1
    v_exp_f32 v193, v29
    v_exp_f32 v194, v30
    v_exp_f32 v195, v31
    s_waitcnt lgkmcnt(2)
    v_mfma_f32_32x32x16_bf16 v[16:31], v[176:179], v[8:11], 0
    v_exp_f32 v32, v32
    v_exp_f32 v33, v33
    v_exp_f32 v34, v34
    s_waitcnt lgkmcnt(0)
    v_smfmac_f32_32x32x32_bf16 v[48:63], v[184:187], v[188:195], v245
    v_exp_f32 v35, v35
    v_exp_f32 v36, v36
    v_exp_f32 v37, v37
    v_mfma_f32_32x32x16_bf16 v[96:111], v[172:175], v[160:163], v[96:111]
    s_xor_b32 s64, s48, 65536
    buffer_load_dwordx4 v[160:163], v246, s[16:19], s64 offen offset:0 sc1
    v_exp_f32 v38, v38
    v_exp_f32 v39, v39
    v_exp_f32 v188, v40
    v_exp_f32 v189, v41
    v_smfmac_f32_32x32x32_bf16 v[64:79], v[180:183], v[32:39], v245
    ds_read_b64_tr_b16 v[180:181], v249 offset:45408
    ds_read_b64_tr_b16 v[182:183], v250 offset:45408
    v_exp_f32 v190, v42
    v_exp_f32 v191, v43
    v_exp_f32 v192, v44
    v_mfma_f32_32x32x16_bf16 v[128:143], v[172:175], v[164:167], v[128:143]
    s_xor_b32 s64, s48, 65536
    buffer_load_dwordx4 v[172:175], v247, s[16:19], s64 offen offset:0 sc1
    v_exp_f32 v193, v45
    v_exp_f32 v194, v46
    v_exp_f32 v195, v47
    v_mfma_f32_32x32x16_bf16 v[32:47], v[176:179], v[12:15], 0
    ds_read_b128 v[176:179], v248 offset:49536
    v_exp_f32 v16, v16
    v_exp_f32 v17, v17
    v_exp_f32 v18, v18
    v_exp_f32 v19, v19
    v_smfmac_f32_32x32x32_bf16 v[64:79], v[184:187], v[188:195], v245
    ds_read_b64_tr_b16 v[184:185], v251 offset:45408
    ds_read_b64_tr_b16 v[186:187], v252 offset:45408
    v_exp_f32 v20, v20
    v_exp_f32 v21, v21
    v_exp_f32 v22, v22
    v_exp_f32 v23, v23
    v_mfma_f32_32x32x16_bf16 v[112:127], v[168:171], v[164:167], v[112:127]
    s_xor_b32 s64, s48, 81920
    buffer_load_dwordx4 v[164:167], v246, s[16:19], s64 offen offset:0 sc1
    v_exp_f32 v188, v24
    v_exp_f32 v189, v25
    v_exp_f32 v190, v26
    v_exp_f32 v191, v27
    s_waitcnt lgkmcnt(3)
    v_smfmac_f32_32x32x32_bf16 v[48:63], v[180:183], v[16:23], v245
    v_exp_f32 v192, v28
    v_exp_f32 v193, v29
    s_xor_b32 s64, s48, 81920
    buffer_load_dwordx4 v[168:171], v247, s[16:19], s64 offen offset:0 sc1
    v_exp_f32 v194, v30
    v_exp_f32 v195, v31
    s_waitcnt lgkmcnt(2)
    v_mfma_f32_32x32x16_bf16 v[16:31], v[176:179], v[8:11], 0
    v_exp_f32 v32, v32
    v_exp_f32 v33, v33
    v_exp_f32 v34, v34
    v_exp_f32 v35, v35
    v_exp_f32 v36, v36
    s_waitcnt lgkmcnt(0)
    v_smfmac_f32_32x32x32_bf16 v[48:63], v[184:187], v[188:195], v245
    s_cmp_lt_u32 s62, 4
    s_cbranch_scc1 HS_34
    s_setprio 1
HS_34:
    s_barrier
    v_exp_f32 v37, v37
    v_exp_f32 v38, v38
    v_exp_f32 v39, v39
    s_xor_b32 s64, s48, 98304
    buffer_load_dwordx4 v[212:215], v246, s[16:19], s64 offen offset:0 sc1
    v_exp_f32 v188, v40
    v_exp_f32 v189, v41
    v_exp_f32 v190, v42
    v_smfmac_f32_32x32x32_bf16 v[64:79], v[180:183], v[32:39], v245
    ds_read_b64_tr_b16 v[180:181], v249 offset:49536
    ds_read_b64_tr_b16 v[182:183], v250 offset:49536
    v_exp_f32 v191, v43
    v_exp_f32 v192, v44
    v_exp_f32 v193, v45
    s_xor_b32 s64, s48, 98304
    buffer_load_dwordx4 v[216:219], v247, s[16:19], s64 offen offset:0 sc1
    v_exp_f32 v194, v46
    v_exp_f32 v195, v47
    v_mfma_f32_32x32x16_bf16 v[32:47], v[176:179], v[12:15], 0
    ds_read_b128 v[176:179], v248 offset:53664
    v_exp_f32 v16, v16
    v_exp_f32 v17, v17
    v_exp_f32 v18, v18
    v_exp_f32 v19, v19
    v_exp_f32 v20, v20
    v_smfmac_f32_32x32x32_bf16 v[64:79], v[184:187], v[188:195], v245
    ds_read_b64_tr_b16 v[184:185], v251 offset:49536
    ds_read_b64_tr_b16 v[186:187], v252 offset:49536
    v_xor_b32 v4, 0x800, v238
    ds_write_b128 v4, v[88:91] offset:0
    v_exp_f32 v21, v21
    v_exp_f32 v22, v22
    v_exp_f32 v23, v23
    s_xor_b32 s64, s48, 114688
    buffer_load_dwordx4 v[220:223], v246, s[16:19], s64 offen offset:0 sc1
    v_exp_f32 v188, v24
    v_exp_f32 v189, v25
    v_exp_f32 v190, v26
    s_waitcnt lgkmcnt(4)
    v_smfmac_f32_32x32x32_bf16 v[48:63], v[180:183], v[16:23], v245
    ds_write_b128 v4, v[92:95] offset:1024
    v_exp_f32 v191, v27
    v_exp_f32 v192, v28
    v_exp_f32 v193, v29
    s_xor_b32 s64, s48, 114688
    buffer_load_dwordx4 v[224:227], v247, s[16:19], s64 offen offset:0 sc1
    v_exp_f32 v194, v30
    v_exp_f32 v195, v31
    s_waitcnt lgkmcnt(4)
    v_mfma_f32_32x32x16_bf16 v[16:31], v[176:179], v[8:11], 0
    v_exp_f32 v32, v32
    v_exp_f32 v33, v33
    v_exp_f32 v34, v34
    v_exp_f32 v35, v35
    v_exp_f32 v36, v36
    s_waitcnt lgkmcnt(2)
    v_smfmac_f32_32x32x32_bf16 v[48:63], v[184:187], v[188:195], v245
    v_xor_b32 v4, 0x1000, v238
    ds_write_b128 v4, v[96:99] offset:16384
    v_exp_f32 v37, v37
    v_exp_f32 v38, v38
    v_exp_f32 v39, v39
    buffer_load_dwordx2 v[228:229], v236, s[28:31], s49 offen
    buffer_load_dwordx2 v[230:231], v236, s[28:31], s49 offen offset:16
    v_exp_f32 v188, v40
    v_exp_f32 v189, v41
    v_exp_f32 v190, v42
    v_smfmac_f32_32x32x32_bf16 v[64:79], v[180:183], v[32:39], v245
    ds_read_b64_tr_b16 v[180:181], v249 offset:53664
    ds_read_b64_tr_b16 v[182:183], v250 offset:53664
    ds_write_b128 v4, v[100:103] offset:17408
    v_exp_f32 v191, v43
    v_exp_f32 v192, v44
    v_exp_f32 v193, v45
    v_and_b32 v236, 31, v1
    v_lshlrev_b32 v236, 2, v236
    buffer_load_dword v236, v236, s[16:19], s50 offen sc1
    v_exp_f32 v194, v46
    v_exp_f32 v195, v47
    v_mfma_f32_32x32x16_bf16 v[32:47], v[176:179], v[12:15], 0
    ds_read_b128 v[176:179], v248 offset:57792
    v_exp_f32 v16, v16
    v_exp_f32 v17, v17
    v_exp_f32 v18, v18
    v_exp_f32 v19, v19
    v_exp_f32 v20, v20
    v_smfmac_f32_32x32x32_bf16 v[64:79], v[184:187], v[188:195], v245
    ds_read_b64_tr_b16 v[184:185], v251 offset:53664
    ds_read_b64_tr_b16 v[186:187], v252 offset:53664
    v_xor_b32 v4, 0x1800, v238
    ds_write_b128 v4, v[104:107] offset:32768
    v_exp_f32 v21, v21
    v_exp_f32 v22, v22
    v_exp_f32 v23, v23
PAD25:
    s_cbranch_execz SC_BACK
    buffer_load_dwordx4 v[232:235], v237, s[4:7], s68 offen
    v_exp_f32 v188, v24
    v_exp_f32 v189, v25
    v_exp_f32 v190, v26
    s_waitcnt lgkmcnt(5)
    v_smfmac_f32_32x32x32_bf16 v[48:63], v[180:183], v[16:23], v245
    ds_write_b128 v4, v[108:111] offset:33792
    v_exp_f32 v191, v27
    v_exp_f32 v192, v28
    v_exp_f32 v193, v29
    v_exp_f32 v194, v30
    v_exp_f32 v195, v31
    s_waitcnt lgkmcnt(4)
    v_mfma_f32_32x32x16_bf16 v[16:31], v[176:179], v[8:11], 0
    v_exp_f32 v32, v32
    v_exp_f32 v33, v33
    v_exp_f32 v34, v34
    v_exp_f32 v35, v35
    v_exp_f32 v36, v36
    s_waitcnt lgkmcnt(2)
    v_smfmac_f32_32x32x32_bf16 v[48:63], v[184:187], v[188:195], v245
    v_xor_b32 v4, 0x2000, v238
    ds_write_b128 v4, v[112:115] offset:49152
    v_exp_f32 v37, v37
    v_exp_f32 v38, v38
    v_exp_f32 v39, v39
    v_exp_f32 v188, v40
    v_exp_f32 v189, v41
    v_exp_f32 v190, v42
    v_smfmac_f32_32x32x32_bf16 v[64:79], v[180:183], v[32:39], v245
    ds_read_b64_tr_b16 v[180:181], v249 offset:57792
    ds_read_b64_tr_b16 v[182:183], v250 offset:57792
    ds_write_b128 v4, v[116:119] offset:50176
    v_exp_f32 v191, v43
    v_exp_f32 v192, v44
    v_exp_f32 v193, v45
    v_exp_f32 v194, v46
    v_exp_f32 v195, v47
    s_setprio 0
    v_mfma_f32_32x32x16_bf16 v[32:47], v[176:179], v[12:15], 0
    ds_read_b128 v[176:179], v248 offset:61920
    v_exp_f32 v16, v16
    v_exp_f32 v17, v17
    v_exp_f32 v18, v18
    v_exp_f32 v19, v19
    v_exp_f32 v20, v20
    v_smfmac_f32_32x32x32_bf16 v[64:79], v[184:187], v[188:195], v245
    ds_read_b64_tr_b16 v[184:185], v251 offset:57792
    ds_read_b64_tr_b16 v[186:187], v252 offset:57792
    v_xor_b32 v4, 0x12800, v238
    ds_write_b128 v4, v[120:123] offset:0
    v_exp_f32 v21, v21
    v_exp_f32 v22, v22
    v_exp_f32 v23, v23
    v_exp_f32 v188, v24
    v_exp_f32 v189, v25
    v_exp_f32 v190, v26
    s_waitcnt lgkmcnt(5)
    v_smfmac_f32_32x32x32_bf16 v[48:63], v[180:183], v[16:23], v245
    ds_write_b128 v4, v[124:127] offset:1024
    v_exp_f32 v191, v27
    v_exp_f32 v192, v28
    v_exp_f32 v193, v29
    v_exp_f32 v194, v30
    v_exp_f32 v195, v31
    s_waitcnt lgkmcnt(4)
    v_mfma_f32_32x32x16_bf16 v[16:31], v[176:179], v[8:11], 0
    v_exp_f32 v32, v32
    v_exp_f32 v33, v33
    v_exp_f32 v34, v34
    v_exp_f32 v35, v35
    v_exp_f32 v36, v36
    s_waitcnt lgkmcnt(2)
    v_smfmac_f32_32x32x32_bf16 v[48:63], v[184:187], v[188:195], v245
    v_xor_b32 v4, 0x13000, v238
    ds_write_b128 v4, v[128:131] offset:16384
    v_exp_f32 v37, v37
    v_exp_f32 v38, v38
    v_exp_f32 v39, v39
    v_exp_f32 v188, v40
    v_exp_f32 v189, v41
    v_exp_f32 v190, v42
    v_smfmac_f32_32x32x32_bf16 v[64:79], v[180:183], v[32:39], v245
    ds_read_b64_tr_b16 v[180:181], v249 offset:61920
    ds_read_b64_tr_b16 v[182:183], v250 offset:61920
    ds_write_b128 v4, v[132:135] offset:17408
    v_exp_f32 v191, v43
    v_exp_f32 v192, v44
    v_exp_f32 v193, v45
    v_exp_f32 v194, v46
    v_exp_f32 v195, v47
    v_mfma_f32_32x32x16_bf16 v[32:47], v[176:179], v[12:15], 0
    v_exp_f32 v16, v16
    v_exp_f32 v17, v17
    v_exp_f32 v18, v18
    v_exp_f32 v19, v19
    v_exp_f32 v20, v20
    v_smfmac_f32_32x32x32_bf16 v[64:79], v[184:187], v[188:195], v245
    ds_read_b64_tr_b16 v[184:185], v251 offset:61920
    ds_read_b64_tr_b16 v[186:187], v252 offset:61920
    v_xor_b32 v4, 0x13800, v238
    ds_write_b128 v4, v[136:139] offset:32768
    v_exp_f32 v21, v21
    v_exp_f32 v22, v22
    v_exp_f32 v23, v23
    v_exp_f32 v188, v24
    v_exp_f32 v189, v25
    v_exp_f32 v190, v26
    s_waitcnt lgkmcnt(4)
    v_smfmac_f32_32x32x32_bf16 v[48:63], v[180:183], v[16:23], v245
    ds_write_b128 v4, v[140:143] offset:33792
    v_exp_f32 v191, v27
    v_exp_f32 v192, v28
    v_exp_f32 v193, v29
    v_exp_f32 v194, v30
    v_exp_f32 v195, v31
    v_exp_f32 v32, v32
    v_exp_f32 v33, v33
    v_exp_f32 v34, v34
    v_exp_f32 v35, v35
    v_exp_f32 v36, v36
    s_waitcnt lgkmcnt(2)
    v_smfmac_f32_32x32x32_bf16 v[48:63], v[184:187], v[188:195], v245
    v_exp_f32 v37, v37
    v_exp_f32 v38, v38
    v_exp_f32 v39, v39
    v_exp_f32 v188, v40
    v_exp_f32 v189, v41
    v_exp_f32 v190, v42
    v_smfmac_f32_32x32x32_bf16 v[64:79], v[180:183], v[32:39], v245
    v_exp_f32 v191, v43
    v_exp_f32 v192, v44
    v_exp_f32 v193, v45
    v_exp_f32 v194, v46
    v_exp_f32 v195, v47
    ds_write_b128 v5, v[48:51]
    ds_write_b128 v5, v[52:55] offset:1024
    ds_write_b32 v5, v56 offset:2048
    s_mov_b32 s65, 0x21800000
    s_mov_b32 s66, 0x5d800000
    s_mov_b32 s54, 0x7b800000
    s_mov_b32 s56, 0xbfb8aa3b
    v_smfmac_f32_32x32x32_bf16 v[64:79], v[184:187], v[188:195], v245
    v_add_u32 v7, 0x10000, v238
    s_waitcnt lgkmcnt(0)
    s_barrier
    s_setprio 2
    ds_read_b32 v184, v6 offset:2048
    ds_read_b128 v[176:179], v6
    ds_read_b128 v[180:183], v6 offset:1024
    ds_read_b128 v[88:91], v238 offset:0
    ds_read_b128 v[92:95], v238 offset:1024
    ds_read_b128 v[96:99], v238 offset:16384
    ds_read_b128 v[100:103], v238 offset:17408
    ds_read_b128 v[104:107], v238 offset:32768
    ds_read_b128 v[108:111], v238 offset:33792
    ds_read_b128 v[112:115], v238 offset:49152
    ds_read_b128 v[116:119], v238 offset:50176
    ds_read_b128 v[120:123], v7 offset:0
    ds_read_b128 v[124:127], v7 offset:1024
    ds_read_b128 v[128:131], v7 offset:16384
    ds_read_b128 v[132:135], v7 offset:17408
    s_waitcnt lgkmcnt(14)
    v_add_f32 v72, v72, v184
    v_rcp_f32 v36, v72
    s_waitcnt lgkmcnt(12)
    v_pk_add_f32 v[64:65], v[64:65], v[176:177]
    v_pk_add_f32 v[66:67], v[66:67], v[178:179]
    v_pk_add_f32 v[68:69], v[68:69], v[180:181]
    v_pk_add_f32 v[70:71], v[70:71], v[182:183]
    ds_read_b128 v[136:139], v7 offset:32768
    ds_read_b128 v[140:143], v7 offset:33792
    v_pk_add_f32 v[32:33], v[64:65], v[68:69]
    v_pk_add_f32 v[34:35], v[66:67], v[70:71]
    v_cmp_le_f32 s[96:97], s65, v72
    v_pk_add_f32 v[32:33], v[32:33], v[34:35]
    v_cmp_ge_f32 s[98:99], s66, v72
    v_add_f32 v32, v32, v33
    v_pk_mul_f32 v[64:65], v[36:37], v[64:65] op_sel_hi:[0,1]
    v_cmp_gt_f32 vcc, s54, |v32|
    v_pk_mul_f32 v[66:67], v[36:37], v[66:67] op_sel_hi:[0,1]
    v_pk_mul_f32 v[68:69], v[36:37], v[68:69] op_sel_hi:[0,1]
    v_pk_mul_f32 v[70:71], v[36:37], v[70:71] op_sel_hi:[0,1]
    s_and_b64 s[96:97], s[96:97], s[98:99]
    s_and_b64 s[96:97], s[96:97], vcc
    s_cmp_eq_u64 s[96:97], exec
    s_cbranch_scc0 SLOW
T_OST:
    v_cvt_pk_bf16_f32 v176, v64, v65
    v_cvt_pk_bf16_f32 v177, v66, v67
    v_cvt_pk_bf16_f32 v178, v68, v69
PAD26:
    s_cbranch_execz SC_BACK
    v_cvt_pk_bf16_f32 v179, v70, v71
    buffer_store_dwordx4 v[176:179], v2, s[16:19], s88 offen sc1
    s_setprio 0
    s_mov_b32 s95, 4000
    s_movk_i32 s84, 255
    s_waitcnt vmcnt(1)
    v_lshlrev_b32 v188, 16, v228
    v_and_b32 v189, s73, v228
    v_lshlrev_b32 v190, 16, v229
    v_and_b32 v191, s73, v229
    v_lshlrev_b32 v192, 16, v230
    v_and_b32 v193, s73, v230
    v_lshlrev_b32 v194, 16, v231
    v_and_b32 v195, s73, v231
    v_permlane32_swap_b32 v232, v234
    v_permlane32_swap_b32 v233, v235
    v_lshlrev_b32 v248, 16, v232
    v_and_b32 v249, s73, v232
    v_lshlrev_b32 v250, 16, v233
    v_and_b32 v251, s73, v233
    v_lshlrev_b32 v252, 16, v234
    v_and_b32 v253, s73, v234
    v_lshlrev_b32 v254, 16, v235
    v_and_b32 v255, s73, v235
    s_waitcnt lgkmcnt(12)
    v_pk_add_f32 v[80:81], v[80:81], v[88:89]
    v_pk_add_f32 v[82:83], v[82:83], v[90:91]
    v_pk_add_f32 v[84:85], v[84:85], v[92:93]
    v_pk_add_f32 v[86:87], v[86:87], v[94:95]
    s_waitcnt lgkmcnt(10)
    v_pk_add_f32 v[80:81], v[80:81], v[96:97]
    v_pk_add_f32 v[82:83], v[82:83], v[98:99]
    v_pk_add_f32 v[84:85], v[84:85], v[100:101]
    v_pk_add_f32 v[86:87], v[86:87], v[102:103]
    s_waitcnt lgkmcnt(8)
    v_pk_add_f32 v[80:81], v[80:81], v[104:105]
    v_pk_add_f32 v[82:83], v[82:83], v[106:107]
    v_pk_add_f32 v[84:85], v[84:85], v[108:109]
    v_pk_add_f32 v[86:87], v[86:87], v[110:111]
    s_waitcnt lgkmcnt(6)
    v_pk_add_f32 v[80:81], v[80:81], v[112:113]
    v_pk_add_f32 v[82:83], v[82:83], v[114:115]
    v_pk_add_f32 v[84:85], v[84:85], v[116:117]
    v_pk_add_f32 v[86:87], v[86:87], v[118:119]
    s_waitcnt lgkmcnt(4)
    v_pk_add_f32 v[80:81], v[80:81], v[120:121]
    v_pk_add_f32 v[82:83], v[82:83], v[122:123]
    v_pk_add_f32 v[84:85], v[84:85], v[124:125]
    v_pk_add_f32 v[86:87], v[86:87], v[126:127]
    s_waitcnt lgkmcnt(2)
    v_pk_add_f32 v[80:81], v[80:81], v[128:129]
    buffer_load_dwordx4 v[16:19], v2, s[16:19], s51 offen offset:0 sc1
    v_pk_add_f32 v[82:83], v[82:83], v[130:131]
    v_pk_add_f32 v[84:85], v[84:85], v[132:133]
    v_pk_add_f32 v[86:87], v[86:87], v[134:135]
    s_waitcnt lgkmcnt(0)
    v_pk_add_f32 v[80:81], v[80:81], v[136:137]
    buffer_load_dwordx4 v[20:23], v2, s[16:19], s51 offen offset:1024 sc1
    v_pk_add_f32 v[82:83], v[82:83], v[138:139]
    v_pk_add_f32 v[84:85], v[84:85], v[140:141]
    v_pk_add_f32 v[86:87], v[86:87], v[142:143]
    v_pk_fma_f32 v[188:189], v[80:81], v[236:237], v[188:189] op_sel_hi:[1,0,1]
    v_pk_fma_f32 v[190:191], v[82:83], v[236:237], v[190:191] op_sel_hi:[1,0,1]
    buffer_load_dwordx4 v[24:27], v2, s[16:19], s51 offen offset:2048 sc1
    v_pk_fma_f32 v[192:193], v[84:85], v[236:237], v[192:193] op_sel_hi:[1,0,1]
    v_pk_fma_f32 v[194:195], v[86:87], v[236:237], v[194:195] op_sel_hi:[1,0,1]
    v_pk_mul_f32 v[80:81], s[56:57], v[188:189] op_sel_hi:[0,1]
    v_pk_mul_f32 v[82:83], s[56:57], v[190:191] op_sel_hi:[0,1]
    v_pk_mul_f32 v[84:85], s[56:57], v[192:193] op_sel_hi:[0,1]
    buffer_load_dwordx4 v[28:31], v2, s[16:19], s51 offen offset:3072 sc1
    v_pk_mul_f32 v[86:87], s[56:57], v[194:195] op_sel_hi:[0,1]
    v_exp_f32 v80, v80
    v_exp_f32 v81, v81
    v_exp_f32 v82, v82
    v_exp_f32 v83, v83
    buffer_load_dwordx4 v[32:35], v2, s[16:19], s52 offen offset:0 sc1
    v_exp_f32 v84, v84
    v_exp_f32 v85, v85
    v_exp_f32 v86, v86
    v_exp_f32 v87, v87
    v_pk_add_f32 v[80:81], 1.0, v[80:81] op_sel_hi:[0,1]
    buffer_load_dwordx4 v[36:39], v2, s[16:19], s52 offen offset:1024 sc1
    v_pk_add_f32 v[82:83], 1.0, v[82:83] op_sel_hi:[0,1]
    v_pk_add_f32 v[84:85], 1.0, v[84:85] op_sel_hi:[0,1]
    v_pk_add_f32 v[86:87], 1.0, v[86:87] op_sel_hi:[0,1]
    v_rcp_f32 v80, v80
    v_rcp_f32 v81, v81
    buffer_load_dwordx4 v[40:43], v2, s[16:19], s52 offen offset:2048 sc1
    v_rcp_f32 v82, v82
    v_rcp_f32 v83, v83
    v_rcp_f32 v84, v84
    v_rcp_f32 v85, v85
    v_rcp_f32 v86, v86
    buffer_load_dwordx4 v[44:47], v2, s[16:19], s52 offen offset:3072 sc1
    v_rcp_f32 v87, v87
    v_pk_mul_f32 v[188:189], v[80:81], v[188:189]
    v_pk_mul_f32 v[190:191], v[82:83], v[190:191]
    v_pk_mul_f32 v[192:193], v[84:85], v[192:193]
    v_pk_mul_f32 v[194:195], v[86:87], v[194:195]
    v_xor_b32 v5, 2048, v238
    v_xor_b32 v6, 4096, v238
    v_xor_b32 v7, 6144, v238
    s_waitcnt vmcnt(7)
    v_cmp_eq_u32 vcc, -1, v16
    s_nop 1
    s_cbranch_vccnz T_Z0
    v_mfma_f32_32x32x16_bf16 v[48:63], v[196:199], v[16:19], 0
    v_mfma_f32_32x32x16_bf16 v[64:79], v[208:211], v[16:19], 0
    s_movk_i32 s84, 254
    s_branch T_NX0
T_RND:
    s_bitcmp1_b32 s84, 0
    s_cbranch_scc0 T_NX0
    s_waitcnt vmcnt(7)
    v_cmp_eq_u32 vcc, -1, v16
    s_nop 1
    s_cbranch_vccnz T_NX0
T_GO0:
    v_mfma_f32_32x32x16_bf16 v[48:63], v[196:199], v[16:19], v[48:63]
    v_mfma_f32_32x32x16_bf16 v[64:79], v[208:211], v[16:19], v[64:79]
    s_bitset0_b32 s84, 0
T_NX0:
    s_bitcmp1_b32 s84, 1
    s_cbranch_scc0 T_NX1
    s_waitcnt vmcnt(6)
    v_cmp_eq_u32 vcc, -1, v20
    s_nop 1
    s_cbranch_vccnz T_NX1
T_GO1:
    v_mfma_f32_32x32x16_bf16 v[48:63], v[200:203], v[20:23], v[48:63]
    v_mfma_f32_32x32x16_bf16 v[64:79], v[204:207], v[20:23], v[64:79]
    s_bitset0_b32 s84, 1
T_NX1:
    s_bitcmp1_b32 s84, 2
    s_cbranch_scc0 T_NX2
    s_waitcnt vmcnt(5)
    v_cmp_eq_u32 vcc, -1, v24
    s_nop 1
    s_cbranch_vccnz T_NX2
T_GO2:
    v_mfma_f32_32x32x16_bf16 v[48:63], v[144:147], v[24:27], v[48:63]
    v_mfma_f32_32x32x16_bf16 v[64:79], v[156:159], v[24:27], v[64:79]
    s_bitset0_b32 s84, 2
T_NX2:
    s_bitcmp1_b32 s84, 3
    s_cbranch_scc0 T_NX3
    s_waitcnt vmcnt(4)
    v_cmp_eq_u32 vcc, -1, v28
PAD27:
    s_cbranch_execz SC_BACK
QAD8:
    s_cbranch_execz VRET
    s_nop 1
    s_cbranch_vccnz T_NX3
T_GO3:
    v_mfma_f32_32x32x16_bf16 v[48:63], v[148:151], v[28:31], v[48:63]
    v_mfma_f32_32x32x16_bf16 v[64:79], v[152:155], v[28:31], v[64:79]
    s_bitset0_b32 s84, 3
T_NX3:
    s_bitcmp1_b32 s84, 4
    s_cbranch_scc0 T_NX4
    s_waitcnt vmcnt(3)
    v_cmp_eq_u32 vcc, -1, v32
    s_nop 1
    s_cbranch_vccnz T_NX4
T_GO4:
    v_mfma_f32_32x32x16_bf16 v[48:63], v[160:163], v[32:35], v[48:63]
    v_mfma_f32_32x32x16_bf16 v[64:79], v[172:175], v[32:35], v[64:79]
    s_bitset0_b32 s84, 4
T_NX4:
    s_bitcmp1_b32 s84, 5
    s_cbranch_scc0 T_NX5
    s_waitcnt vmcnt(2)
    v_cmp_eq_u32 vcc, -1, v36
    s_nop 1
    s_cbranch_vccnz T_NX5
T_GO5:
    v_mfma_f32_32x32x16_bf16 v[48:63], v[164:167], v[36:39], v[48:63]
    v_mfma_f32_32x32x16_bf16 v[64:79], v[168:171], v[36:39], v[64:79]
    s_bitset0_b32 s84, 5
T_NX5:
    s_bitcmp1_b32 s84, 6
    s_cbranch_scc0 T_NX6
    s_waitcnt vmcnt(1)
    v_cmp_eq_u32 vcc, -1, v40
    s_nop 1
    s_cbranch_vccnz T_NX6
T_GO6:
    v_mfma_f32_32x32x16_bf16 v[48:63], v[212:215], v[40:43], v[48:63]
    v_mfma_f32_32x32x16_bf16 v[64:79], v[216:219], v[40:43], v[64:79]
    s_bitset0_b32 s84, 6
T_NX6:
    s_bitcmp1_b32 s84, 7
    s_cbranch_scc0 T_NX7
    s_waitcnt vmcnt(0)
    v_cmp_eq_u32 vcc, -1, v44
    s_nop 1
    s_cbranch_vccnz T_NX7
T_GO7:
    v_mfma_f32_32x32x16_bf16 v[48:63], v[220:223], v[44:47], v[48:63]
    v_mfma_f32_32x32x16_bf16 v[64:79], v[224:227], v[44:47], v[64:79]
    s_bitset0_b32 s84, 7
T_NX7:
    s_cmp_lg_u32 s84, 0
    s_cbranch_scc1 T_AG
T_UP:
    s_nop 7
    ds_write_b128 v238, v[56:59] offset:0
    ds_write_b128 v238, v[60:63] offset:1024
    ds_write_b128 v238, v[64:67] offset:16384
    ds_write_b128 v238, v[68:71] offset:17408
    ds_write_b128 v238, v[72:75] offset:32768
    ds_write_b128 v238, v[76:79] offset:33792
    s_waitcnt lgkmcnt(0)
    s_barrier
    ds_read_b128 v[56:59], v5 offset:0
    ds_read_b128 v[60:63], v5 offset:1024
    ds_read_b128 v[64:67], v6 offset:16384
    ds_read_b128 v[68:71], v6 offset:17408
    ds_read_b128 v[72:75], v7 offset:32768
    ds_read_b128 v[76:79], v7 offset:33792
    s_waitcnt lgkmcnt(4)
    v_pk_add_f32 v[48:49], v[48:49], v[56:57]
    v_pk_add_f32 v[50:51], v[50:51], v[58:59]
    v_pk_add_f32 v[52:53], v[52:53], v[60:61]
    v_pk_add_f32 v[54:55], v[54:55], v[62:63]
    s_waitcnt lgkmcnt(2)
    v_pk_add_f32 v[48:49], v[48:49], v[64:65]
    v_pk_add_f32 v[50:51], v[50:51], v[66:67]
    v_pk_add_f32 v[52:53], v[52:53], v[68:69]
    v_pk_add_f32 v[54:55], v[54:55], v[70:71]
    s_waitcnt lgkmcnt(0)
    v_pk_add_f32 v[48:49], v[48:49], v[72:73]
    v_pk_add_f32 v[50:51], v[50:51], v[74:75]
    v_pk_add_f32 v[52:53], v[52:53], v[76:77]
    v_pk_add_f32 v[54:55], v[54:55], v[78:79]
    v_pk_fma_f32 v[248:249], v[48:49], v[188:189], v[248:249]
    v_pk_fma_f32 v[250:251], v[50:51], v[190:191], v[250:251]
    v_pk_fma_f32 v[252:253], v[52:53], v[192:193], v[252:253]
    v_pk_fma_f32 v[254:255], v[54:55], v[194:195], v[254:255]
    v_cvt_pk_bf16_f32 v232, v248, v249
    v_cvt_pk_bf16_f32 v233, v250, v251
    v_cvt_pk_bf16_f32 v234, v252, v253
    v_cvt_pk_bf16_f32 v235, v254, v255
    s_nop 0
    v_permlane32_swap_b32 v232, v234
    v_permlane32_swap_b32 v233, v235
    buffer_store_dwordx4 v[232:235], v237, s[36:39], s68 offen
END:
    s_endpgm
T_Z0:
    v_mov_b32 v48, 0
    v_mov_b32 v49, 0
    v_mov_b32 v50, 0
    v_mov_b32 v51, 0
    v_mov_b32 v52, 0
    v_mov_b32 v53, 0
    v_mov_b32 v54, 0
    v_mov_b32 v55, 0
    v_mov_b32 v56, 0
    v_mov_b32 v57, 0
    v_mov_b32 v58, 0
    v_mov_b32 v59, 0
    v_mov_b32 v60, 0
    v_mov_b32 v61, 0
    v_mov_b32 v62, 0
    v_mov_b32 v63, 0
    v_mov_b32 v64, 0
    v_mov_b32 v65, 0
    v_mov_b32 v66, 0
    v_mov_b32 v67, 0
    v_mov_b32 v68, 0
    v_mov_b32 v69, 0
    v_mov_b32 v70, 0
    v_mov_b32 v71, 0
    v_mov_b32 v72, 0
    v_mov_b32 v73, 0
    v_mov_b32 v74, 0
    v_mov_b32 v75, 0
    v_mov_b32 v76, 0
    v_mov_b32 v77, 0
    v_mov_b32 v78, 0
    v_mov_b32 v79, 0
    s_branch T_NX0
T_AG:
    s_sub_u32 s95, s95, 1
    s_cbranch_scc1 T_UP
    s_bitcmp1_b32 s84, 0
    s_cbranch_scc0 T_NL0
    buffer_load_dwordx4 v[16:19], v2, s[16:19], s51 offen offset:0 sc1
T_NL0:
    s_bitcmp1_b32 s84, 1
    s_cbranch_scc0 T_NL1
    buffer_load_dwordx4 v[20:23], v2, s[16:19], s51 offen offset:1024 sc1
T_NL1:
    s_bitcmp1_b32 s84, 2
    s_cbranch_scc0 T_NL2
    buffer_load_dwordx4 v[24:27], v2, s[16:19], s51 offen offset:2048 sc1
T_NL2:
    s_bitcmp1_b32 s84, 3
    s_cbranch_scc0 T_NL3
    buffer_load_dwordx4 v[28:31], v2, s[16:19], s51 offen offset:3072 sc1
T_NL3:
    s_bitcmp1_b32 s84, 4
    s_cbranch_scc0 T_NL4
    buffer_load_dwordx4 v[32:35], v2, s[16:19], s52 offen offset:0 sc1
T_NL4:
    s_bitcmp1_b32 s84, 5
    s_cbranch_scc0 T_NL5
    buffer_load_dwordx4 v[36:39], v2, s[16:19], s52 offen offset:1024 sc1
T_NL5:
    s_bitcmp1_b32 s84, 6
    s_cbranch_scc0 T_NL6
    buffer_load_dwordx4 v[40:43], v2, s[16:19], s52 offen offset:2048 sc1
T_NL6:
    s_bitcmp1_b32 s84, 7
    s_cbranch_scc0 T_NL7
    buffer_load_dwordx4 v[44:47], v2, s[16:19], s52 offen offset:3072 sc1
T_NL7:
    s_waitcnt vmcnt(0)
    s_branch T_RND
SLOW:
    s_lshr_b32 s64, s62, 2
    s_sub_u32 s64, s62, s64
    s_add_u32 s64, s64, 56
    s_mul_i32 s64, s64, 2064
    v_add_u32 v249, s64, v249
    v_subrev_u32 v249, 66048, v249
    v_add_u32 v250, s64, v250
    v_subrev_u32 v250, 66048, v250
    v_add_u32 v251, s64, v251
    v_subrev_u32 v251, 66048, v251
    v_add_u32 v252, s64, v252
    v_subrev_u32 v252, 66048, v252
    s_add_u32 s64, s62, 56
    s_mul_i32 s64, s64, 2064
    s_add_u32 m0, s64, 1024
    s_and_b32 s65, s81, 0x1f0000
    s_add_u32 s65, s65, 0x200000
    v_mov_b32 v48, 0xff800000
    s_mov_b32 s84, 0
SL1:
    s_add_u32 s66, s65, s84
    buffer_load_dwordx4 v[176:179], v2, s[16:19], s66 offen sc1
    s_waitcnt vmcnt(0)
    v_mfma_f32_32x32x16_bf16 v[16:31], v[176:179], v[12:15], 0
    s_nop 15
    v_max3_f32 v48, v16, v17, v48
    v_max3_f32 v48, v18, v19, v48
    v_max3_f32 v48, v20, v21, v48
    v_max3_f32 v48, v22, v23, v48
    v_max3_f32 v48, v24, v25, v48
    v_max3_f32 v48, v26, v27, v48
    v_max3_f32 v48, v28, v29, v48
    v_max3_f32 v48, v30, v31, v48
    s_add_u32 s84, s84, 1024
    s_cmp_lt_u32 s84, 65536
    s_cbranch_scc1 SL1
    v_mov_b32 v49, v48
    s_nop 1
    v_permlane32_swap_b32 v48, v49
    v_max_f32 v48, v48, v49
    v_sub_f32 v32, 0, v48
    v_mov_b32 v64, 0
    v_sub_f32 v33, 0, v48
    v_mov_b32 v65, 0
    v_sub_f32 v34, 0, v48
    v_mov_b32 v66, 0
    v_sub_f32 v35, 0, v48
    v_mov_b32 v67, 0
    v_sub_f32 v36, 0, v48
    v_mov_b32 v68, 0
    v_sub_f32 v37, 0, v48
    v_mov_b32 v69, 0
    v_sub_f32 v38, 0, v48
    v_mov_b32 v70, 0
    v_sub_f32 v39, 0, v48
    v_mov_b32 v71, 0
    v_sub_f32 v40, 0, v48
    v_mov_b32 v72, 0
    v_sub_f32 v41, 0, v48
    v_mov_b32 v73, 0
    v_sub_f32 v42, 0, v48
    v_mov_b32 v74, 0
    v_sub_f32 v43, 0, v48
    v_mov_b32 v75, 0
    v_sub_f32 v44, 0, v48
    v_mov_b32 v76, 0
    v_sub_f32 v45, 0, v48
    v_mov_b32 v77, 0
    v_sub_f32 v46, 0, v48
    v_mov_b32 v78, 0
    v_sub_f32 v47, 0, v48
    v_mov_b32 v79, 0
    s_mov_b32 s84, 0
SL2:
    s_add_u32 s66, s65, s84
    s_add_u32 s67, s66, 0x200000
    buffer_load_dwordx4 v[176:179], v2, s[16:19], s66 offen sc1
    buffer_load_dwordx4 v2, s[16:19], s67 offen sc1 lds
    s_waitcnt vmcnt(0)
    ds_read_b64_tr_b16 v[180:181], v249
    ds_read_b64_tr_b16 v[182:183], v250
    ds_read_b64_tr_b16 v[184:185], v251
    ds_read_b64_tr_b16 v[186:187], v252
    v_mfma_f32_32x32x16_bf16 v[16:31], v[176:179], v[12:15], v[32:47]
    s_nop 15
    v_exp_f32 v16, v16
    v_exp_f32 v17, v17
    v_exp_f32 v18, v18
    v_exp_f32 v19, v19
    v_exp_f32 v20, v20
    v_exp_f32 v21, v21
    v_exp_f32 v22, v22
    v_exp_f32 v23, v23
    v_exp_f32 v24, v24
    v_exp_f32 v25, v25
    v_exp_f32 v26, v26
    v_exp_f32 v27, v27
    v_exp_f32 v28, v28
    v_exp_f32 v29, v29
    v_exp_f32 v30, v30
    v_exp_f32 v31, v31
    s_nop 0
    s_waitcnt lgkmcnt(0)
    s_nop 0
    v_smfmac_f32_32x32x32_bf16 v[64:79], v[180:183], v[16:23], v245
    v_smfmac_f32_32x32x32_bf16 v[64:79], v[184:187], v[24:31], v245
    s_add_u32 s84, s84, 1024
    s_cmp_lt_u32 s84, 65536
    s_nop 7
    s_cbranch_scc1 SL2
    s_nop 7
    v_rcp_f32 v48, v72
    s_nop 0
    v_mul_f32 v64, v48, v64
    v_mul_f32 v65, v48, v65
    v_mul_f32 v66, v48, v66
    v_mul_f32 v67, v48, v67
    v_mul_f32 v68, v48, v68
    v_mul_f32 v69, v48, v69
    v_mul_f32 v70, v48, v70
    v_mul_f32 v71, v48, v71
    s_branch T_OST
.section .rodata,"a"
.p2align 6
.amdhsa_kernel recurrent_scan__softmax_full_mha__dense_activation_squared_relu__prompt_kernel
  .amdhsa_next_free_vgpr 256
  .amdhsa_next_free_sgpr 102
  .amdhsa_accum_offset 256
  .amdhsa_group_segment_fixed_size 0
  .amdhsa_kernarg_size 88
  .amdhsa_user_sgpr_count 2
  .amdhsa_user_sgpr_kernarg_segment_ptr 1
  .amdhsa_system_sgpr_workgroup_id_x 1
.end_amdhsa_kernel
```
